```python
import torch

def _softmax(x, axis=-1):
    return torch.softmax(x, dim=axis)
def _gelu(x):
    return torch.nn.functional.gelu(x, approximate="tanh")
def _silu(x):
    return torch.nn.functional.silu(x)
def _sigmoid(x):
    return torch.sigmoid(x)
def _layernorm(x, axis=-1, eps=1e-5):
    m = x.mean(dim=axis, keepdim=True)
    v = x.var(dim=axis, keepdim=True, unbiased=False)
    return (x - m) / torch.sqrt(v + eps)
def _scatter_add(tgt, idx, src, axis=0):
    return tgt.clone().index_add_(axis, idx, src)
def _segment_sum(src, seg, n):
    out = torch.zeros((n,) + src.shape[1:], dtype=src.dtype)
    return out.index_add_(0, seg, src)
def _pad(x, pw):
    flat = tuple(v for pair in reversed(pw) for v in pair)
    return torch.nn.functional.pad(x, flat)

kernel_name = 'gated_mix__linear_kernel_hedgehog__grouped_kv_mqa__prompt'

def setup_inputs():

    _w = (lambda a: (lambda t: t.to(torch.bfloat16) if t.is_floating_point() else t)(torch.as_tensor(a)))
    def _A_setup():
        B, S, D, H = 1, 2048, 640, 32
        Dh = D // H
        return {
            "x": _w((lambda *s: torch.randn(*s, dtype=torch.bfloat16) * 0.05)(B, S, D)),
            "wqkv": _w((lambda *s: torch.randn(*s, dtype=torch.bfloat16) * 1.6)(D, 3 * D)),
            "w_phi": _w((lambda *s: torch.randn(*s, dtype=torch.bfloat16) * 1.6)(H, Dh, Dh) * (Dh ** -0.5)),
            "wo": _w((lambda *s: torch.randn(*s, dtype=torch.bfloat16) * 0.05)(D, D)),
        }
    _A_in = _A_setup()

    def _B_setup():
        B, S, D, H = 1, 2048, 640, 32
        Dh = D // H
        return {
            "x": _w((lambda *s: torch.randn(*s, dtype=torch.bfloat16) * 0.05)(B, S, D)),
            "wq": _w((lambda *s: torch.randn(*s, dtype=torch.bfloat16) * 1.6)(D, H * Dh)),
            "wk": _w((lambda *s: torch.randn(*s, dtype=torch.bfloat16) * 1.6)(D, Dh)),
            "wv": _w((lambda *s: torch.randn(*s, dtype=torch.bfloat16) * 0.05)(D, Dh)),
            "wo": _w((lambda *s: torch.randn(*s, dtype=torch.bfloat16) * 0.05)(H * Dh, D)),
        }
    _B_in = _B_setup()

    return {
        "A_x": _A_in["x"],
        "A_wqkv": _A_in["wqkv"],
        "A_w_phi": _A_in["w_phi"],
        "A_wo": _A_in["wo"],
        "B_x": _B_in["x"],
        "B_wq": _B_in["wq"],
        "B_wk": _B_in["wk"],
        "B_wv": _B_in["wv"],
        "B_wo": _B_in["wo"],
        "gate_w": _w((lambda *s: torch.randn(*s, dtype=torch.bfloat16) * 0.05)(640) * 16.0),
    }

def reference(A_x, A_wqkv, A_w_phi, A_wo, B_x, B_wq, B_wk, B_wv, B_wo, gate_w):
    def _A_ref(x, wqkv, w_phi, wo):
        B, S, D = x.shape
        H = 32; Dh = D // H
        qkv = (lambda x, *d: x.permute(*d))((x @ wqkv).reshape(B, S, 3, H, Dh), 2, 0, 3, 1, 4)
        q, k, v = qkv[0], qkv[1], qkv[2]
        pq = torch.einsum("bhsd,hdf->bhsf", q, w_phi)
        pk = torch.einsum("bhsd,hdf->bhsf", k, w_phi)
        phi_q = torch.concatenate([_softmax(pq, axis=-1), _softmax(-pq, axis=-1)], axis=-1)
        phi_k = torch.concatenate([_softmax(pk, axis=-1), _softmax(-pk, axis=-1)], axis=-1)
        kv = torch.einsum("bhsf,bhsd->bhfd", phi_k, v)
        z  = torch.einsum("bhsf->bhf", phi_k)
        num = torch.einsum("bhqf,bhfd->bhqd", phi_q, kv)
        den = torch.einsum("bhqf,bhf->bhq", phi_q, z)[..., None] + 1e-6
        o = num / den
        return (lambda x, *d: x.permute(*d))(o, 0, 2, 1, 3).reshape(B, S, D) @ wo

    def _B_ref(x, wq, wk, wv, wo):
        B, S, D = x.shape
        H = 32
        Dh = D // H
        q = (lambda x, *d: x.permute(*d))((x @ wq).reshape(B, S, H, Dh), 0, 2, 1, 3)
        k = x @ wk
        v = x @ wv
        scores = torch.einsum("bhqd,bkd->bhqk", q, k) * (Dh ** -0.5)
        p = _softmax(scores, axis=-1)
        o = torch.einsum("bhqk,bkd->bhqd", p, v)
        return (lambda x, *d: x.permute(*d))(o, 0, 2, 1, 3).reshape(B, S, H * Dh) @ wo

    x = A_x
    g = _sigmoid((x * gate_w).sum(-1, keepdims=True))
    a = _A_ref(x, A_wqkv, A_w_phi, A_wo)
    b = _B_ref(x, B_wq, B_wk, B_wv, B_wo)
    return g * a + (1 - g) * b
```

```asm
; @launch kernel=fused_kernel grid=(256,1,1) block=(768,1,1) lds=163840
.amdgcn_target "amdgcn-amd-amdhsa--gfx950"
.text
.globl fused_kernel
.p2align 8
.type fused_kernel,@function
fused_kernel:
    s_cmp_ge_u32 s2, 256
    s_cbranch_scc1 F_END
    s_load_dwordx8 s[4:11], s[0:1], 0
    s_load_dwordx8 s[12:19], s[0:1], 40
    s_load_dwordx8 s[20:27], s[0:1], 72
    s_getpc_b64 s[58:59]
F_PC:
    s_sub_u32 s58, s58, F_PC-fused_kernel
    s_subb_u32 s59, s59, 0
    s_bfe_u32 s56, s2, 0x10003
    s_mul_i32 s56, s56, 12288
    v_lshlrev_b32 v2, 4, v0
    v_add_u32 v2, s56, v2
    v_min_u32 v2, F_END-fused_kernel-16, v2
    global_load_dwordx4 v[164:167], v2, s[58:59]
    v_lshrrev_b32 v2, 6, v0
    v_and_b32 v1, 63, v0
    s_and_b32 s3, s2, 7
    v_readfirstlane_b32 s28, v2
    s_lshr_b32 s56, s2, 3
    s_lshl_b32 s29, s3, 2
    s_lshr_b32 s57, s56, 3
    s_add_u32 s29, s29, s57
    s_and_b32 s30, s56, 7
    s_mul_i32 s31, s57, 3
    s_add_u32 s31, s31, s30
    s_cmp_ge_u32 s31, 10
    s_cselect_b32 s57, 10, 0
    s_sub_u32 s31, s31, s57
    v_mov_b32 v23, 163328
    v_mov_b32 v24, 1
    s_mov_b32 s71, 100000
    v_lshlrev_b32 v2, 2, v0
    v_mov_b32 v3, 0
    v_add_u32 v2, 163328, v2
    s_cmp_lg_u32 s28, 0
    s_cbranch_scc1 F_NOINIT
    ds_write_b32 v2, v3
F_NOINIT:
    s_waitcnt lgkmcnt(0)
    s_mov_b32 s32, s26
    s_mov_b32 s33, s27
    s_mov_b32 s34, 33554432
    s_mov_b32 s35, 0x20000
    s_mov_b32 s48, s24
    s_mov_b32 s49, s25
    s_mov_b32 s50, 256
    s_mov_b32 s51, 0x20000
    s_cmp_ge_u32 s28, 8
    s_cbranch_scc1 F_G
    s_cmp_ge_u32 s28, 7
    s_cbranch_scc1 F_W7
    s_cmp_ge_u32 s28, 5
    s_cbranch_scc1 F_XLD
    s_barrier
    s_mul_i32 s56, s30, 160
    s_add_u32 s44, s12, s56
    s_addc_u32 s45, s13, 0
    s_sub_u32 s46, 819200, s56
    s_mov_b32 s47, 0x20000
    s_lshl_b32 s56, s28, 7
    s_movk_i32 s57, 6554
    v_add_u32 v2, s56, v1
    v_add_u32 v2, 0, v2
    v_mul_u32_u24 v3, s57, v2
    v_lshrrev_b32 v3, 16, v3
    v_mul_u32_u24 v4, 10, v3
    v_sub_u32 v4, v2, v4
    v_and_b32 v5, 0x33, v3
    v_and_b32 v6, 4, v3
    v_lshl_or_b32 v5, v6, 1, v5
    v_and_b32 v6, 8, v3
    v_lshrrev_b32 v6, 1, v6
    v_or_b32 v5, v5, v6
    v_mul_u32_u24 v5, 1280, v5
    v_lshl_add_u32 v8, v4, 4, v5
    v_add_u32 v2, s56, v1
    v_add_u32 v2, 64, v2
    v_mul_u32_u24 v3, s57, v2
    v_lshrrev_b32 v3, 16, v3
    v_mul_u32_u24 v4, 10, v3
    v_sub_u32 v4, v2, v4
    v_and_b32 v5, 0x33, v3
    v_and_b32 v6, 4, v3
    v_lshl_or_b32 v5, v6, 1, v5
    v_and_b32 v6, 8, v3
    v_lshrrev_b32 v6, 1, v6
    v_or_b32 v5, v5, v6
    v_mul_u32_u24 v5, 1280, v5
    v_lshl_add_u32 v9, v4, 4, v5
    v_subrev_u32 v9, 1024, v9
    s_mul_i32 s58, s31, 81920
    s_lshl_b32 s59, s28, 11
    s_add_u32 s59, s59, 81920
LW_1:
    ds_read_b32 v25, v23 offset:176
    s_waitcnt lgkmcnt(0)
    v_readfirstlane_b32 s70, v25
    s_cmp_ge_u32 s70, 4
    s_cbranch_scc1 LD_2
    s_sleep 1
    s_sub_u32 s71, s71, 1
    s_cbranch_scc0 LW_1
    s_mov_b32 s71, 0
LD_2:
    s_add_u32 m0, s59, 0
    s_nop 0
    buffer_load_dwordx4 v8, s[44:47], s58 offen lds
    buffer_load_dwordx4 v9, s[44:47], s58 offen offset:1024 lds
    s_add_u32 s58, s58, 81920
    s_cmp_eq_u32 s58, 819200
    s_cselect_b32 s58, 0, s58
    s_add_u32 m0, s59, 10240
    s_nop 0
    buffer_load_dwordx4 v8, s[44:47], s58 offen lds
    buffer_load_dwordx4 v9, s[44:47], s58 offen offset:1024 lds
    s_add_u32 s58, s58, 81920
    s_cmp_eq_u32 s58, 819200
    s_cselect_b32 s58, 0, s58
    s_add_u32 m0, s59, 20480
    s_nop 0
    buffer_load_dwordx4 v8, s[44:47], s58 offen lds
    buffer_load_dwordx4 v9, s[44:47], s58 offen offset:1024 lds
    s_add_u32 s58, s58, 81920
    s_cmp_eq_u32 s58, 819200
    s_cselect_b32 s58, 0, s58
    s_waitcnt vmcnt(4)
    s_mov_b64 exec, 1
    ds_add_u32 v23, v24 offset:0
    s_mov_b64 exec, -1
    s_add_u32 m0, s59, 30720
    s_nop 0
    buffer_load_dwordx4 v8, s[44:47], s58 offen lds
    buffer_load_dwordx4 v9, s[44:47], s58 offen offset:1024 lds
    s_add_u32 s58, s58, 81920
    s_cmp_eq_u32 s58, 819200
    s_cselect_b32 s58, 0, s58
    s_waitcnt vmcnt(4)
    s_mov_b64 exec, 1
    ds_add_u32 v23, v24 offset:4
    s_mov_b64 exec, -1
LW_3:
    ds_read_b32 v25, v23 offset:180
    s_waitcnt lgkmcnt(0)
    v_readfirstlane_b32 s70, v25
    s_cmp_ge_u32 s70, 1
    s_cbranch_scc1 LD_4
    s_sleep 1
    s_sub_u32 s71, s71, 1
    s_cbranch_scc0 LW_3
    s_mov_b32 s71, 0
LD_4:
    s_add_u32 m0, s59, 40960
    s_nop 0
    buffer_load_dwordx4 v8, s[44:47], s58 offen lds
    buffer_load_dwordx4 v9, s[44:47], s58 offen offset:1024 lds
    s_add_u32 s58, s58, 81920
    s_cmp_eq_u32 s58, 819200
    s_cselect_b32 s58, 0, s58
    s_waitcnt vmcnt(4)
    s_mov_b64 exec, 1
    ds_add_u32 v23, v24 offset:8
    s_mov_b64 exec, -1
LW_5:
    ds_read_b32 v25, v23 offset:128
    s_waitcnt lgkmcnt(0)
    v_readfirstlane_b32 s70, v25
    s_cmp_ge_u32 s70, 4
    s_cbranch_scc1 LD_6
    s_sleep 1
    s_sub_u32 s71, s71, 1
    s_cbranch_scc0 LW_5
    s_mov_b32 s71, 0
LD_6:
    s_add_u32 m0, s59, 0
    s_nop 0
    buffer_load_dwordx4 v8, s[44:47], s58 offen lds
    buffer_load_dwordx4 v9, s[44:47], s58 offen offset:1024 lds
    s_add_u32 s58, s58, 81920
    s_cmp_eq_u32 s58, 819200
    s_cselect_b32 s58, 0, s58
    s_waitcnt vmcnt(4)
    s_mov_b64 exec, 1
    ds_add_u32 v23, v24 offset:12
    s_mov_b64 exec, -1
LW_7:
    ds_read_b32 v25, v23 offset:132
    s_waitcnt lgkmcnt(0)
    v_readfirstlane_b32 s70, v25
    s_cmp_ge_u32 s70, 4
    s_cbranch_scc1 LD_8
    s_sleep 1
    s_sub_u32 s71, s71, 1
    s_cbranch_scc0 LW_7
    s_mov_b32 s71, 0
LD_8:
    s_add_u32 m0, s59, 10240
    s_nop 0
    buffer_load_dwordx4 v8, s[44:47], s58 offen lds
    buffer_load_dwordx4 v9, s[44:47], s58 offen offset:1024 lds
    s_add_u32 s58, s58, 81920
    s_cmp_eq_u32 s58, 819200
    s_cselect_b32 s58, 0, s58
    s_waitcnt vmcnt(4)
    s_mov_b64 exec, 1
    ds_add_u32 v23, v24 offset:16
    s_mov_b64 exec, -1
LW_9:
    ds_read_b32 v25, v23 offset:136
    s_waitcnt lgkmcnt(0)
    v_readfirstlane_b32 s70, v25
    s_cmp_ge_u32 s70, 4
    s_cbranch_scc1 LD_10
    s_sleep 1
    s_sub_u32 s71, s71, 1
    s_cbranch_scc0 LW_9
    s_mov_b32 s71, 0
LD_10:
    s_add_u32 m0, s59, 20480
    s_nop 0
    buffer_load_dwordx4 v8, s[44:47], s58 offen lds
    buffer_load_dwordx4 v9, s[44:47], s58 offen offset:1024 lds
    s_add_u32 s58, s58, 81920
    s_cmp_eq_u32 s58, 819200
    s_cselect_b32 s58, 0, s58
    s_waitcnt vmcnt(4)
    s_mov_b64 exec, 1
    ds_add_u32 v23, v24 offset:20
    s_mov_b64 exec, -1
LW_11:
    ds_read_b32 v25, v23 offset:140
    s_waitcnt lgkmcnt(0)
    v_readfirstlane_b32 s70, v25
    s_cmp_ge_u32 s70, 4
    s_cbranch_scc1 LD_12
    s_sleep 1
    s_sub_u32 s71, s71, 1
    s_cbranch_scc0 LW_11
    s_mov_b32 s71, 0
LD_12:
    s_add_u32 m0, s59, 30720
    s_nop 0
    buffer_load_dwordx4 v8, s[44:47], s58 offen lds
    buffer_load_dwordx4 v9, s[44:47], s58 offen offset:1024 lds
    s_add_u32 s58, s58, 81920
    s_cmp_eq_u32 s58, 819200
    s_cselect_b32 s58, 0, s58
    s_waitcnt vmcnt(4)
    s_mov_b64 exec, 1
    ds_add_u32 v23, v24 offset:24
    s_mov_b64 exec, -1
LW_13:
    ds_read_b32 v25, v23 offset:144
    s_waitcnt lgkmcnt(0)
    v_readfirstlane_b32 s70, v25
    s_cmp_ge_u32 s70, 4
    s_cbranch_scc1 LD_14
    s_sleep 1
    s_sub_u32 s71, s71, 1
    s_cbranch_scc0 LW_13
    s_mov_b32 s71, 0
LD_14:
    s_add_u32 m0, s59, 40960
    s_nop 0
    buffer_load_dwordx4 v8, s[44:47], s58 offen lds
    buffer_load_dwordx4 v9, s[44:47], s58 offen offset:1024 lds
    s_add_u32 s58, s58, 81920
    s_cmp_eq_u32 s58, 819200
    s_cselect_b32 s58, 0, s58
    s_waitcnt vmcnt(4)
    s_mov_b64 exec, 1
    ds_add_u32 v23, v24 offset:28
    s_mov_b64 exec, -1
    s_waitcnt vmcnt(2)
    s_mov_b64 exec, 1
    ds_add_u32 v23, v24 offset:32
    s_mov_b64 exec, -1
    s_waitcnt vmcnt(0)
    s_mov_b64 exec, 1
    ds_add_u32 v23, v24 offset:36
    s_mov_b64 exec, -1
    s_branch F_ATT
F_XLD:
    s_setprio 3
    s_mul_i32 s56, s29, 81920
    s_add_u32 s36, s4, s56
    s_addc_u32 s37, s5, 0
    s_mov_b32 s38, 81920
    s_mov_b32 s39, 0x20000
    s_sub_u32 s56, s28, 5
    s_and_b32 s57, s30, 3
    s_lshl_b32 s57, s57, 1
    s_add_u32 s57, s57, s56
    v_lshrrev_b32 v2, 3, v1
    v_and_b32 v3, 7, v1
    v_lshrrev_b32 v4, 4, v1
    v_xor_b32 v3, v3, v4
    s_lshl_b32 s58, s56, 2
    v_xor_b32 v3, s58, v3
    v_mul_u32_u24 v2, 1280, v2
    v_lshl_add_u32 v8, v3, 4, v2
    s_add_u32 s58, s57, 0
    s_and_b32 s58, s58, 7
    s_mul_i32 s60, s58, 10240
    s_lshl_b32 s64, s58, 10
    s_add_u32 s58, s57, 2
    s_and_b32 s58, s58, 7
    s_mul_i32 s61, s58, 10240
    s_lshl_b32 s65, s58, 10
    s_add_u32 s58, s57, 4
    s_and_b32 s58, s58, 7
    s_mul_i32 s62, s58, 10240
    s_lshl_b32 s66, s58, 10
    s_add_u32 s58, s57, 6
    s_and_b32 s58, s58, 7
    s_mul_i32 s63, s58, 10240
    s_lshl_b32 s67, s58, 10
    s_add_u32 m0, s64, 0
    s_add_u32 s58, s60, 0
    buffer_load_dwordx4 v8, s[36:39], s58 offen lds
    s_add_u32 m0, s64, 8192
    s_add_u32 s58, s60, 128
    buffer_load_dwordx4 v8, s[36:39], s58 offen lds
    s_add_u32 m0, s64, 16384
    s_add_u32 s58, s60, 256
    buffer_load_dwordx4 v8, s[36:39], s58 offen lds
    s_add_u32 m0, s64, 24576
    s_add_u32 s58, s60, 384
    buffer_load_dwordx4 v8, s[36:39], s58 offen lds
    s_add_u32 m0, s64, 32768
    s_add_u32 s58, s60, 512
    buffer_load_dwordx4 v8, s[36:39], s58 offen lds
    s_barrier
    s_add_u32 m0, s64, 40960
    s_add_u32 s58, s60, 640
    buffer_load_dwordx4 v8, s[36:39], s58 offen lds
    s_add_u32 m0, s64, 49152
    s_add_u32 s58, s60, 768
    buffer_load_dwordx4 v8, s[36:39], s58 offen lds
    s_add_u32 m0, s64, 57344
    s_add_u32 s58, s60, 896
    buffer_load_dwordx4 v8, s[36:39], s58 offen lds
    s_add_u32 m0, s64, 65536
    s_add_u32 s58, s60, 1024
    buffer_load_dwordx4 v8, s[36:39], s58 offen lds
    s_add_u32 m0, s64, 73728
    s_add_u32 s58, s60, 1152
    buffer_load_dwordx4 v8, s[36:39], s58 offen lds
    s_mov_b64 exec, 1
    ds_add_u32 v23, v24 offset:176
    s_mov_b64 exec, -1
    s_setprio 0
    s_lshl_b32 s68, s31, 7
    s_lshl_b32 s69, s31, 13
    s_waitcnt vmcnt(0)
    s_mov_b64 exec, 1
    ds_add_u32 v23, v24 offset:40
    s_mov_b64 exec, -1
    s_add_u32 m0, s65, s69
    s_add_u32 s58, s61, s68
    buffer_load_dwordx4 v8, s[36:39], s58 offen lds
    s_add_u32 m0, s66, s69
    s_add_u32 s58, s62, s68
    buffer_load_dwordx4 v8, s[36:39], s58 offen lds
    s_add_u32 m0, s67, s69
    s_add_u32 s58, s63, s68
    buffer_load_dwordx4 v8, s[36:39], s58 offen lds
    s_add_u32 s68, s68, 128
    s_add_u32 s69, s69, 8192
    s_cmp_eq_u32 s68, 1280
    s_cselect_b32 s68, 0, s68
    s_cselect_b32 s69, 0, s69
    s_add_u32 m0, s65, s69
    s_add_u32 s58, s61, s68
    buffer_load_dwordx4 v8, s[36:39], s58 offen lds
    s_add_u32 m0, s66, s69
    s_add_u32 s58, s62, s68
    buffer_load_dwordx4 v8, s[36:39], s58 offen lds
    s_add_u32 m0, s67, s69
    s_add_u32 s58, s63, s68
    buffer_load_dwordx4 v8, s[36:39], s58 offen lds
    s_add_u32 s68, s68, 128
    s_add_u32 s69, s69, 8192
    s_cmp_eq_u32 s68, 1280
    s_cselect_b32 s68, 0, s68
    s_cselect_b32 s69, 0, s69
    s_add_u32 m0, s65, s69
    s_add_u32 s58, s61, s68
    buffer_load_dwordx4 v8, s[36:39], s58 offen lds
    s_add_u32 m0, s66, s69
    s_add_u32 s58, s62, s68
    buffer_load_dwordx4 v8, s[36:39], s58 offen lds
    s_add_u32 m0, s67, s69
    s_add_u32 s58, s63, s68
    buffer_load_dwordx4 v8, s[36:39], s58 offen lds
    s_add_u32 s68, s68, 128
    s_add_u32 s69, s69, 8192
    s_cmp_eq_u32 s68, 1280
    s_cselect_b32 s68, 0, s68
    s_cselect_b32 s69, 0, s69
    s_waitcnt vmcnt(6)
    s_mov_b64 exec, 1
    ds_add_u32 v23, v24 offset:0
    s_mov_b64 exec, -1
    s_add_u32 m0, s65, s69
    s_add_u32 s58, s61, s68
    buffer_load_dwordx4 v8, s[36:39], s58 offen lds
    s_add_u32 m0, s66, s69
    s_add_u32 s58, s62, s68
    buffer_load_dwordx4 v8, s[36:39], s58 offen lds
    s_add_u32 m0, s67, s69
    s_add_u32 s58, s63, s68
    buffer_load_dwordx4 v8, s[36:39], s58 offen lds
    s_add_u32 s68, s68, 128
    s_add_u32 s69, s69, 8192
    s_cmp_eq_u32 s68, 1280
    s_cselect_b32 s68, 0, s68
    s_cselect_b32 s69, 0, s69
    s_waitcnt vmcnt(6)
    s_mov_b64 exec, 1
    ds_add_u32 v23, v24 offset:4
    s_mov_b64 exec, -1
    s_add_u32 m0, s65, s69
    s_add_u32 s58, s61, s68
    buffer_load_dwordx4 v8, s[36:39], s58 offen lds
    s_add_u32 m0, s66, s69
    s_add_u32 s58, s62, s68
    buffer_load_dwordx4 v8, s[36:39], s58 offen lds
    s_add_u32 m0, s67, s69
    s_add_u32 s58, s63, s68
    buffer_load_dwordx4 v8, s[36:39], s58 offen lds
    s_add_u32 s68, s68, 128
    s_add_u32 s69, s69, 8192
    s_cmp_eq_u32 s68, 1280
    s_cselect_b32 s68, 0, s68
    s_cselect_b32 s69, 0, s69
    s_waitcnt vmcnt(6)
    s_mov_b64 exec, 1
    ds_add_u32 v23, v24 offset:8
    s_mov_b64 exec, -1
    s_add_u32 m0, s65, s69
    s_add_u32 s58, s61, s68
    buffer_load_dwordx4 v8, s[36:39], s58 offen lds
    s_add_u32 m0, s66, s69
    s_add_u32 s58, s62, s68
    buffer_load_dwordx4 v8, s[36:39], s58 offen lds
    s_add_u32 m0, s67, s69
    s_add_u32 s58, s63, s68
    buffer_load_dwordx4 v8, s[36:39], s58 offen lds
    s_add_u32 s68, s68, 128
    s_add_u32 s69, s69, 8192
    s_cmp_eq_u32 s68, 1280
    s_cselect_b32 s68, 0, s68
    s_cselect_b32 s69, 0, s69
    s_waitcnt vmcnt(6)
    s_mov_b64 exec, 1
    ds_add_u32 v23, v24 offset:12
    s_mov_b64 exec, -1
    s_add_u32 m0, s65, s69
    s_add_u32 s58, s61, s68
    buffer_load_dwordx4 v8, s[36:39], s58 offen lds
    s_add_u32 m0, s66, s69
    s_add_u32 s58, s62, s68
    buffer_load_dwordx4 v8, s[36:39], s58 offen lds
    s_add_u32 m0, s67, s69
    s_add_u32 s58, s63, s68
    buffer_load_dwordx4 v8, s[36:39], s58 offen lds
    s_add_u32 s68, s68, 128
    s_add_u32 s69, s69, 8192
    s_cmp_eq_u32 s68, 1280
    s_cselect_b32 s68, 0, s68
    s_cselect_b32 s69, 0, s69
    s_waitcnt vmcnt(6)
    s_mov_b64 exec, 1
    ds_add_u32 v23, v24 offset:16
    s_mov_b64 exec, -1
    s_add_u32 m0, s65, s69
    s_add_u32 s58, s61, s68
    buffer_load_dwordx4 v8, s[36:39], s58 offen lds
    s_add_u32 m0, s66, s69
    s_add_u32 s58, s62, s68
    buffer_load_dwordx4 v8, s[36:39], s58 offen lds
    s_add_u32 m0, s67, s69
    s_add_u32 s58, s63, s68
    buffer_load_dwordx4 v8, s[36:39], s58 offen lds
    s_add_u32 s68, s68, 128
    s_add_u32 s69, s69, 8192
    s_cmp_eq_u32 s68, 1280
    s_cselect_b32 s68, 0, s68
    s_cselect_b32 s69, 0, s69
    s_waitcnt vmcnt(6)
    s_mov_b64 exec, 1
    ds_add_u32 v23, v24 offset:20
    s_mov_b64 exec, -1
    s_add_u32 m0, s65, s69
    s_add_u32 s58, s61, s68
    buffer_load_dwordx4 v8, s[36:39], s58 offen lds
    s_add_u32 m0, s66, s69
    s_add_u32 s58, s62, s68
    buffer_load_dwordx4 v8, s[36:39], s58 offen lds
    s_add_u32 m0, s67, s69
    s_add_u32 s58, s63, s68
    buffer_load_dwordx4 v8, s[36:39], s58 offen lds
    s_add_u32 s68, s68, 128
    s_add_u32 s69, s69, 8192
    s_cmp_eq_u32 s68, 1280
    s_cselect_b32 s68, 0, s68
    s_cselect_b32 s69, 0, s69
    s_waitcnt vmcnt(6)
    s_mov_b64 exec, 1
    ds_add_u32 v23, v24 offset:24
    s_mov_b64 exec, -1
    s_add_u32 m0, s65, s69
    s_add_u32 s58, s61, s68
    buffer_load_dwordx4 v8, s[36:39], s58 offen lds
    s_add_u32 m0, s66, s69
    s_add_u32 s58, s62, s68
    buffer_load_dwordx4 v8, s[36:39], s58 offen lds
    s_add_u32 m0, s67, s69
    s_add_u32 s58, s63, s68
    buffer_load_dwordx4 v8, s[36:39], s58 offen lds
    s_add_u32 s68, s68, 128
    s_add_u32 s69, s69, 8192
    s_cmp_eq_u32 s68, 1280
    s_cselect_b32 s68, 0, s68
    s_cselect_b32 s69, 0, s69
    s_waitcnt vmcnt(6)
    s_mov_b64 exec, 1
    ds_add_u32 v23, v24 offset:28
    s_mov_b64 exec, -1
    s_waitcnt vmcnt(3)
    s_mov_b64 exec, 1
    ds_add_u32 v23, v24 offset:32
    s_mov_b64 exec, -1
    s_waitcnt vmcnt(0)
    s_mov_b64 exec, 1
    ds_add_u32 v23, v24 offset:36
    s_mov_b64 exec, -1
    s_cmp_lg_u32 s28, 5
    s_cbranch_scc1 F_ATT
    s_and_b32 s58, s2, 7
    s_lshl_b32 s58, s58, 10
    s_add_u32 s58, s58, 3866624
    v_lshlrev_b32 v3, 7, v1
    v_add_u32 v3, s58, v3
LW_15:
    ds_read_b32 v25, v23 offset:56
    s_waitcnt lgkmcnt(0)
    v_readfirstlane_b32 s70, v25
    s_cmp_ge_u32 s70, 2
    s_cbranch_scc1 LD_16
    s_sleep 2
    s_sub_u32 s71, s71, 1
    s_cbranch_scc0 LW_15
    s_mov_b32 s71, 0
LD_16:
    s_mov_b64 exec, 0xff
GP_17:
    buffer_load_dword v25, v3, s[32:35], 0 offen offset:0 sc1
    s_waitcnt vmcnt(0)
    v_cmp_gt_u32 vcc, 32, v25
    s_nop 1
    s_cmp_eq_u64 vcc, 0
    s_cbranch_scc1 GD_18
    s_sleep 12
    s_sub_u32 s71, s71, 1
    s_cbranch_scc0 GP_17
    s_mov_b32 s71, 0
GD_18:
    s_mov_b64 exec, -1
    v_lshlrev_b32 v3, 3, v1
    v_add_u32 v3, 212992, v3
    buffer_load_dwordx2 v[72:73], v3, s[32:35], 0 offen sc1
    buffer_load_dwordx2 v[74:75], v3, s[32:35], 0 offen offset:512 sc1
    v_lshlrev_b32 v2, 4, v1
    s_mov_b32 m0, 138240
    s_mov_b32 s58, 0
    buffer_load_dwordx4 v2, s[32:35], s58 offen offset:0 sc1 lds
    buffer_load_dwordx4 v2, s[32:35], s58 offen offset:1024 sc1 lds
    buffer_load_dwordx4 v2, s[32:35], s58 offen offset:2048 sc1 lds
    buffer_load_dwordx4 v2, s[32:35], s58 offen offset:3072 sc1 lds
    s_mov_b32 m0, 142336
    s_mov_b32 s58, 4096
    buffer_load_dwordx4 v2, s[32:35], s58 offen offset:0 sc1 lds
    buffer_load_dwordx4 v2, s[32:35], s58 offen offset:1024 sc1 lds
    buffer_load_dwordx4 v2, s[32:35], s58 offen offset:2048 sc1 lds
    buffer_load_dwordx4 v2, s[32:35], s58 offen offset:3072 sc1 lds
    s_mov_b32 m0, 146432
    s_mov_b32 s58, 8192
    buffer_load_dwordx4 v2, s[32:35], s58 offen offset:0 sc1 lds
    buffer_load_dwordx4 v2, s[32:35], s58 offen offset:1024 sc1 lds
    buffer_load_dwordx4 v2, s[32:35], s58 offen offset:2048 sc1 lds
    buffer_load_dwordx4 v2, s[32:35], s58 offen offset:3072 sc1 lds
    s_mov_b32 m0, 150528
    s_mov_b32 s58, 12288
    buffer_load_dwordx4 v2, s[32:35], s58 offen offset:0 sc1 lds
    buffer_load_dwordx4 v2, s[32:35], s58 offen offset:1024 sc1 lds
    buffer_load_dwordx4 v2, s[32:35], s58 offen offset:2048 sc1 lds
    buffer_load_dwordx4 v2, s[32:35], s58 offen offset:3072 sc1 lds
    s_mov_b32 m0, 154624
    s_mov_b32 s58, 16384
    buffer_load_dwordx4 v2, s[32:35], s58 offen offset:0 sc1 lds
    buffer_load_dwordx4 v2, s[32:35], s58 offen offset:1024 sc1 lds
    buffer_load_dwordx4 v2, s[32:35], s58 offen offset:2048 sc1 lds
    buffer_load_dwordx4 v2, s[32:35], s58 offen offset:3072 sc1 lds
    s_mov_b32 m0, 158720
    s_mov_b32 s58, 20480
    buffer_load_dwordx4 v2, s[32:35], s58 offen offset:0 sc1 lds
    s_waitcnt vmcnt(21)
    v_max_f32 v72, v72, v73
    v_max_f32 v74, v74, v75
    s_nop 1
    v_max_f32_dpp v72, v72, v72 row_ror:8 row_mask:0xf bank_mask:0xf
    v_max_f32_dpp v74, v74, v74 row_ror:8 row_mask:0xf bank_mask:0xf
    s_nop 0
    v_max_f32_dpp v72, v72, v72 row_ror:4 row_mask:0xf bank_mask:0xf
    v_max_f32_dpp v74, v74, v74 row_ror:4 row_mask:0xf bank_mask:0xf
    s_nop 0
    v_max_f32_dpp v72, v72, v72 row_ror:2 row_mask:0xf bank_mask:0xf
    v_max_f32_dpp v74, v74, v74 row_ror:2 row_mask:0xf bank_mask:0xf
    s_nop 0
    v_max_f32_dpp v72, v72, v72 row_ror:1 row_mask:0xf bank_mask:0xf
    v_max_f32_dpp v74, v74, v74 row_ror:1 row_mask:0xf bank_mask:0xf
    s_nop 0
    v_mov_b32 v73, v72
    v_mov_b32 v75, v74
    s_nop 1
    v_permlane16_swap_b32 v72, v73
    v_permlane16_swap_b32 v74, v75
    s_nop 1
    v_max_f32 v72, v72, v73
    v_max_f32 v74, v74, v75
    v_mov_b32 v73, v72
    v_mov_b32 v75, v74
    s_nop 1
    v_permlane32_swap_b32 v72, v73
    v_permlane32_swap_b32 v74, v75
    s_nop 1
    v_max_f32 v72, v72, v73
    v_max_f32 v74, v74, v75
    v_add_f32 v72, v72, v74
    ds_write_b32 v23, v72 offset:124
    s_waitcnt vmcnt(0) lgkmcnt(0)
    s_mov_b64 exec, 1
    ds_add_u32 v23, v24 offset:48
    s_mov_b64 exec, -1
    s_branch F_ATT
F_W7:
    s_setprio 2
    s_mov_b32 s40, s6
    s_mov_b32 s41, s7
    s_mov_b32 s42, 2457600
    s_mov_b32 s43, 0x20000
    s_mov_b32 s52, s20
    s_mov_b32 s53, s21
    s_mov_b32 s54, 1280
    s_mov_b32 s55, 0x20000
    s_mul_i32 s56, s30, 3200
    s_add_u32 s44, s8, s56
    s_addc_u32 s45, s9, 0
    s_mov_b32 s46, 3200
    s_mov_b32 s47, 0x20000
    v_lshlrev_b32 v9, 4, v1
    s_mov_b32 m0, 159744
    v_and_b32 v2, 31, v1
    buffer_load_dwordx4 v9, s[44:47], 0 offen lds
    buffer_load_dwordx4 v9, s[44:47], 0 offen offset:1024 lds
    buffer_load_dwordx4 v9, s[44:47], 0 offen offset:2048 lds
    s_mov_b64 exec, 0xff
    buffer_load_dwordx4 v9, s[44:47], 0 offen offset:3072 lds
    s_mov_b64 exec, -1
    s_barrier
    s_movk_i32 s57, 6554
    v_add_u32 v3, 0, v1
    v_mul_u32_u24 v4, s57, v3
    v_lshrrev_b32 v4, 16, v4
    v_mul_u32_u24 v5, 3680, v4
    v_lshl_add_u32 v26, v1, 4, v5
    v_add_u32 v3, 64, v1
    v_mul_u32_u24 v4, s57, v3
    v_lshrrev_b32 v4, 16, v4
    v_mul_u32_u24 v5, 3680, v4
    v_lshl_add_u32 v27, v1, 4, v5
    v_add_u32 v3, 128, v1
    v_mul_u32_u24 v4, s57, v3
    v_lshrrev_b32 v4, 16, v4
    v_mul_u32_u24 v5, 3680, v4
    v_lshl_add_u32 v28, v1, 4, v5
    v_add_u32 v3, 192, v1
    v_mul_u32_u24 v4, s57, v3
    v_lshrrev_b32 v4, 16, v4
    v_mul_u32_u24 v5, 3680, v4
    v_lshl_add_u32 v29, v1, 4, v5
    v_add_u32 v3, 256, v1
    v_mul_u32_u24 v4, s57, v3
    v_lshrrev_b32 v4, 16, v4
    v_mul_u32_u24 v5, 3680, v4
    v_lshl_add_u32 v30, v3, 4, v5
    s_cmp_ge_u32 s29, 10
    s_cselect_b32 s62, 1, 0
    s_cmp_ge_u32 s29, 20
    s_addc_u32 s62, s62, 0
    s_mul_i32 s56, s62, 10
    s_sub_u32 s63, s29, s56
    s_mul_i32 s56, s63, 245760
    s_mul_i32 s57, s62, 1280
    s_add_u32 s56, s56, s57
    s_mul_i32 s57, s30, 160
    s_add_u32 s56, s56, s57
    s_add_u32 s57, s56, 122880
LW_19:
    ds_read_b32 v25, v23 offset:176
    s_waitcnt lgkmcnt(0)
    v_readfirstlane_b32 s70, v25
    s_cmp_ge_u32 s70, 4
    s_cbranch_scc1 LD_20
    s_sleep 1
    s_sub_u32 s71, s71, 1
    s_cbranch_scc0 LW_19
    s_mov_b32 s71, 0
LD_20:
    s_mov_b32 m0, 122880
    s_nop 0
    buffer_load_dwordx4 v26, s[40:43], s56 offen offset:0 lds
    buffer_load_dwordx4 v27, s[40:43], s56 offen offset:1024 lds
    buffer_load_dwordx4 v28, s[40:43], s56 offen offset:2048 lds
    buffer_load_dwordx4 v29, s[40:43], s56 offen offset:3072 lds
    s_mov_b32 m0, 126976
    s_nop 0
    buffer_load_dwordx4 v30, s[40:43], s56 offen lds
    s_mov_b32 m0, 128000
    s_nop 0
    buffer_load_dwordx4 v26, s[40:43], s57 offen offset:0 lds
    buffer_load_dwordx4 v27, s[40:43], s57 offen offset:1024 lds
    buffer_load_dwordx4 v28, s[40:43], s57 offen offset:2048 lds
    buffer_load_dwordx4 v29, s[40:43], s57 offen offset:3072 lds
    s_mov_b32 m0, 132096
    s_nop 0
    buffer_load_dwordx4 v30, s[40:43], s57 offen lds
    s_lshr_b32 s61, s29, 2
    s_mul_i32 s58, s61, 160
    buffer_load_dwordx4 v[88:91], v9, s[52:55], s58 offen
    s_lshl_b32 s58, s2, 7
    s_and_b32 s59, s2, 63
    s_lshl_b32 s59, s59, 7
    s_add_u32 s59, s59, 3833856
    v_mov_b32 v16, s59
    s_add_u32 s59, s58, 3801088
    v_writelane_b32 v16, s59, 1
    v_mov_b32 v17, 0
    s_mov_b64 exec, 3
    buffer_store_dword v17, v16, s[32:35], 0 offen sc1
    s_mov_b64 exec, -1
    v_lshrrev_b32 v3, 5, v1
    v_and_b32 v4, 0x13, v2
    v_and_b32 v5, 4, v2
    v_lshl_or_b32 v4, v5, 1, v4
    v_and_b32 v5, 8, v2
    v_lshrrev_b32 v5, 1, v5
    v_or_b32 v4, v4, v5
    v_mul_u32_u24 v5, 160, v4
    v_add_u32 v5, 122880, v5
    v_lshl_add_u32 v6, v3, 4, v5
    v_add_u32 v12, 5120, v6
    v_lshrrev_b32 v14, 4, v2
    v_bfe_u32 v15, v2, 2, 2
    v_and_b32 v16, 3, v2
    v_mul_u32_u24 v8, 40, v15
    v_lshl_add_u32 v8, v14, 5, v8
    v_lshl_add_u32 v8, v16, 3, v8
    v_add_u32 v8, 159744, v8
    v_mul_u32_u24 v7, 320, v3
    v_add_u32 v7, v7, v8
    v_lshlrev_b32 v11, 5, v2
    v_lshl_add_u32 v11, v3, 4, v11
    v_cmp_gt_u32 vcc, 20, v2
    v_mov_b32 v18, 1073741824
    v_lshrrev_b32 v13, 1, v1
    v_cndmask_b32 v11, v18, v11, vcc
    v_and_b32 v14, 1, v1
    v_lshlrev_b32 v13, 11, v13
    v_lshlrev_b32 v14, 4, v14
    v_cmp_gt_u32 vcc, 10, v1
    v_add_u32 v13, v14, v13
    v_mov_b32 v15, 0x3f80
    v_cndmask_b32 v13, v18, v13, vcc
    v_lshlrev_b32 v15, v14, v15
    v_lshrrev_b32 v16, 1, v2
    v_lshlrev_b32 v17, 2, v3
    v_sub_u32 v17, v16, v17
    v_lshl_add_u32 v16, v3, 6, v16
    s_mul_i32 s64, s30, 327680
    s_lshl_b32 s56, s63, 13
    s_add_u32 s64, s64, s56
    s_mul_i32 s56, s62, 640
    s_add_u32 s64, s64, s56
    s_add_u32 s64, s64, 4194304
    s_cmp_eq_u32 s62, 2
    s_cbranch_scc1 F_W7_ID
    s_waitcnt vmcnt(12)
    v_cmp_eq_u32 vcc, 0, v3
    ds_read_b64_tr_b16 v[92:93], v7 offset:0
    ds_read_b64_tr_b16 v[94:95], v7 offset:160
    ds_read_b64_tr_b16 v[96:97], v8 offset:640
    ds_read_b64_tr_b16 v[98:99], v7 offset:800
    ds_read_b64_tr_b16 v[100:101], v7 offset:960
    ds_read_b64_tr_b16 v[102:103], v8 offset:1440
    ds_read_b64_tr_b16 v[104:105], v7 offset:1600
    ds_read_b64_tr_b16 v[106:107], v7 offset:1760
    ds_read_b64_tr_b16 v[108:109], v8 offset:2240
    ds_read_b64_tr_b16 v[110:111], v7 offset:2400
    ds_read_b64_tr_b16 v[112:113], v7 offset:2560
    ds_read_b64_tr_b16 v[114:115], v8 offset:3040
    s_waitcnt lgkmcnt(0)
    v_cndmask_b32 v96, 0, v96, vcc
    v_cndmask_b32 v97, 0, v97, vcc
    v_cndmask_b32 v102, 0, v102, vcc
    v_cndmask_b32 v103, 0, v103, vcc
    v_cndmask_b32 v108, 0, v108, vcc
    v_cndmask_b32 v109, 0, v109, vcc
    v_cndmask_b32 v114, 0, v114, vcc
    v_cndmask_b32 v115, 0, v115, vcc
    s_branch F_W7_GO
F_W7_ID:
    v_cmp_eq_u32 s[88:89], 0, v17
    v_cmp_eq_u32 s[90:91], 1, v17
    v_cmp_eq_u32 s[92:93], 2, v17
    v_cmp_eq_u32 s[94:95], 3, v17
    s_nop 1
    v_cndmask_b32 v92, 0, v15, s[88:89]
    v_cndmask_b32 v93, 0, v15, s[90:91]
    v_cndmask_b32 v94, 0, v15, s[92:93]
    v_cndmask_b32 v95, 0, v15, s[94:95]
    v_cmp_eq_u32 s[88:89], 8, v16
    v_cmp_eq_u32 s[90:91], 9, v16
    s_nop 1
    v_cndmask_b32 v96, 0, v15, s[88:89]
    v_cndmask_b32 v97, 0, v15, s[90:91]
    v_mov_b32 v98, v92
    v_mov_b32 v99, v93
    v_mov_b32 v100, v94
    v_mov_b32 v101, v95
    v_mov_b32 v102, v96
    v_mov_b32 v103, v97
    v_mov_b32 v104, v92
    v_mov_b32 v105, v93
    v_mov_b32 v106, v94
    v_mov_b32 v107, v95
    v_mov_b32 v108, v96
    v_mov_b32 v109, v97
    v_mov_b32 v110, v92
    v_mov_b32 v111, v93
    v_mov_b32 v112, v94
    v_mov_b32 v113, v95
    v_mov_b32 v114, v96
    v_mov_b32 v115, v97
F_W7_GO:
    s_and_b32 s60, s29, 3
    s_lshl_b32 s56, s30, 2
    s_add_u32 s60, s60, s56
    s_mul_i32 s58, s60, 81920
    s_mul_i32 s59, s61, 10240
    s_add_u32 s58, s58, s59
    s_add_u32 s58, s58, 4196224
    v_mov_b32 v2, 0
    s_waitcnt vmcnt(0)
    buffer_store_dwordx4 v[88:91], v13, s[32:35], s58 offen sc1
    ds_read2_b64 v[40:43], v6 offset0:0 offset1:1
    ds_read_b64 v[72:73], v5 offset:32
    ds_read2_b64 v[44:47], v6 offset0:5 offset1:6
    ds_read_b64 v[74:75], v5 offset:72
    ds_read2_b64 v[48:51], v6 offset0:10 offset1:11
    ds_read_b64 v[76:77], v5 offset:112
    ds_read2_b64 v[52:55], v6 offset0:15 offset1:16
    ds_read_b64 v[78:79], v5 offset:152
    s_waitcnt lgkmcnt(0)
    ds_read2_b64 v[56:59], v12 offset0:0 offset1:1
    ds_read_b64 v[80:81], v5 offset:5152
    ds_read2_b64 v[60:63], v12 offset0:5 offset1:6
    ds_read_b64 v[82:83], v5 offset:5192
    ds_read2_b64 v[64:67], v12 offset0:10 offset1:11
    ds_read_b64 v[84:85], v5 offset:5232
    ds_read2_b64 v[68:71], v12 offset0:15 offset1:16
    ds_read_b64 v[86:87], v5 offset:5272
    s_waitcnt lgkmcnt(0)
    s_mov_b64 exec, 1
    ds_add_u32 v23, v24 offset:180
    s_mov_b64 exec, -1
    s_cmp_ge_u32 s29, 30
    s_cbranch_scc1 F_W7_DONE
    v_mfma_f32_32x32x16_bf16 v[116:131], v[40:43], v[92:95], 0
    v_mfma_f32_32x32x8_bf16 v[116:131], v[72:73], v[96:97], v[116:131]
    v_mfma_f32_32x32x16_bf16 v[132:147], v[44:47], v[98:101], 0
    v_mfma_f32_32x32x8_bf16 v[132:147], v[74:75], v[102:103], v[132:147]
    s_nop 8
    s_add_u32 s58, s64, 0
    v_cvt_pk_bf16_f32 v148, v116, v117
    v_cvt_pk_bf16_f32 v149, v118, v119
    v_cvt_pk_bf16_f32 v150, v120, v121
    v_cvt_pk_bf16_f32 v151, v122, v123
    v_cvt_pk_bf16_f32 v152, v124, v125
    v_cvt_pk_bf16_f32 v153, v126, v127
    v_cvt_pk_bf16_f32 v154, v128, v129
    v_cvt_pk_bf16_f32 v155, v130, v131
    buffer_store_dwordx4 v[148:151], v11, s[32:35], s58 offen sc1
    buffer_store_dwordx4 v[152:155], v11, s[32:35], s58 offen offset:2048 sc1
    v_mfma_f32_32x32x16_bf16 v[116:131], v[48:51], v[104:107], 0
    v_mfma_f32_32x32x8_bf16 v[116:131], v[76:77], v[108:109], v[116:131]
    s_nop 8
    s_add_u32 s58, s64, 81920
    v_cvt_pk_bf16_f32 v156, v132, v133
    v_cvt_pk_bf16_f32 v157, v134, v135
    v_cvt_pk_bf16_f32 v158, v136, v137
    v_cvt_pk_bf16_f32 v159, v138, v139
    v_cvt_pk_bf16_f32 v160, v140, v141
    v_cvt_pk_bf16_f32 v161, v142, v143
    v_cvt_pk_bf16_f32 v162, v144, v145
    v_cvt_pk_bf16_f32 v163, v146, v147
    buffer_store_dwordx4 v[156:159], v11, s[32:35], s58 offen sc1
    buffer_store_dwordx4 v[160:163], v11, s[32:35], s58 offen offset:2048 sc1
    v_mfma_f32_32x32x16_bf16 v[132:147], v[52:55], v[110:113], 0
    v_mfma_f32_32x32x8_bf16 v[132:147], v[78:79], v[114:115], v[132:147]
    s_nop 8
    s_add_u32 s58, s64, 163840
    v_cvt_pk_bf16_f32 v148, v116, v117
    v_cvt_pk_bf16_f32 v149, v118, v119
    v_cvt_pk_bf16_f32 v150, v120, v121
    v_cvt_pk_bf16_f32 v151, v122, v123
    v_cvt_pk_bf16_f32 v152, v124, v125
    v_cvt_pk_bf16_f32 v153, v126, v127
    v_cvt_pk_bf16_f32 v154, v128, v129
    v_cvt_pk_bf16_f32 v155, v130, v131
    buffer_store_dwordx4 v[148:151], v11, s[32:35], s58 offen sc1
    buffer_store_dwordx4 v[152:155], v11, s[32:35], s58 offen offset:2048 sc1
    v_mfma_f32_32x32x16_bf16 v[116:131], v[56:59], v[92:95], 0
    v_mfma_f32_32x32x8_bf16 v[116:131], v[80:81], v[96:97], v[116:131]
    s_nop 8
    s_add_u32 s58, s64, 245760
    v_cvt_pk_bf16_f32 v156, v132, v133
    v_cvt_pk_bf16_f32 v157, v134, v135
    v_cvt_pk_bf16_f32 v158, v136, v137
    v_cvt_pk_bf16_f32 v159, v138, v139
    v_cvt_pk_bf16_f32 v160, v140, v141
    v_cvt_pk_bf16_f32 v161, v142, v143
    v_cvt_pk_bf16_f32 v162, v144, v145
    v_cvt_pk_bf16_f32 v163, v146, v147
    buffer_store_dwordx4 v[156:159], v11, s[32:35], s58 offen sc1
    buffer_store_dwordx4 v[160:163], v11, s[32:35], s58 offen offset:2048 sc1
    v_mfma_f32_32x32x16_bf16 v[132:147], v[60:63], v[98:101], 0
    v_mfma_f32_32x32x8_bf16 v[132:147], v[82:83], v[102:103], v[132:147]
    s_nop 8
    s_add_u32 s58, s64, 4096
    v_cvt_pk_bf16_f32 v148, v116, v117
    v_cvt_pk_bf16_f32 v149, v118, v119
    v_cvt_pk_bf16_f32 v150, v120, v121
    v_cvt_pk_bf16_f32 v151, v122, v123
    v_cvt_pk_bf16_f32 v152, v124, v125
    v_cvt_pk_bf16_f32 v153, v126, v127
    v_cvt_pk_bf16_f32 v154, v128, v129
    v_cvt_pk_bf16_f32 v155, v130, v131
    buffer_store_dwordx4 v[148:151], v11, s[32:35], s58 offen sc1
    buffer_store_dwordx4 v[152:155], v11, s[32:35], s58 offen offset:2048 sc1
    v_mfma_f32_32x32x16_bf16 v[116:131], v[64:67], v[104:107], 0
    v_mfma_f32_32x32x8_bf16 v[116:131], v[84:85], v[108:109], v[116:131]
    s_nop 8
    s_add_u32 s58, s64, 86016
    v_cvt_pk_bf16_f32 v156, v132, v133
    v_cvt_pk_bf16_f32 v157, v134, v135
    v_cvt_pk_bf16_f32 v158, v136, v137
    v_cvt_pk_bf16_f32 v159, v138, v139
    v_cvt_pk_bf16_f32 v160, v140, v141
    v_cvt_pk_bf16_f32 v161, v142, v143
    v_cvt_pk_bf16_f32 v162, v144, v145
    v_cvt_pk_bf16_f32 v163, v146, v147
    buffer_store_dwordx4 v[156:159], v11, s[32:35], s58 offen sc1
    buffer_store_dwordx4 v[160:163], v11, s[32:35], s58 offen offset:2048 sc1
    v_mfma_f32_32x32x16_bf16 v[132:147], v[68:71], v[110:113], 0
    v_mfma_f32_32x32x8_bf16 v[132:147], v[86:87], v[114:115], v[132:147]
    s_nop 8
    s_add_u32 s58, s64, 167936
    v_cvt_pk_bf16_f32 v148, v116, v117
    v_cvt_pk_bf16_f32 v149, v118, v119
    v_cvt_pk_bf16_f32 v150, v120, v121
    v_cvt_pk_bf16_f32 v151, v122, v123
    v_cvt_pk_bf16_f32 v152, v124, v125
    v_cvt_pk_bf16_f32 v153, v126, v127
    v_cvt_pk_bf16_f32 v154, v128, v129
    v_cvt_pk_bf16_f32 v155, v130, v131
    buffer_store_dwordx4 v[148:151], v11, s[32:35], s58 offen sc1
    buffer_store_dwordx4 v[152:155], v11, s[32:35], s58 offen offset:2048 sc1
    s_nop 0
    s_add_u32 s58, s64, 249856
    v_cvt_pk_bf16_f32 v156, v132, v133
    v_cvt_pk_bf16_f32 v157, v134, v135
    v_cvt_pk_bf16_f32 v158, v136, v137
    v_cvt_pk_bf16_f32 v159, v138, v139
    v_cvt_pk_bf16_f32 v160, v140, v141
    v_cvt_pk_bf16_f32 v161, v142, v143
    v_cvt_pk_bf16_f32 v162, v144, v145
    v_cvt_pk_bf16_f32 v163, v146, v147
    buffer_store_dwordx4 v[156:159], v11, s[32:35], s58 offen sc1
    buffer_store_dwordx4 v[160:163], v11, s[32:35], s58 offen offset:2048 sc1
F_W7_DONE:
    s_bfe_u32 s58, s2, 0x30003
    s_lshl_b32 s58, s58, 7
    s_add_u32 s58, s58, 3874816
    v_lshlrev_b32 v4, 10, v1
LW_21:
    ds_read_b32 v25, v23 offset:56
    s_waitcnt lgkmcnt(0)
    v_readfirstlane_b32 s70, v25
    s_cmp_ge_u32 s70, 2
    s_cbranch_scc1 LD_22
    s_sleep 2
    s_sub_u32 s71, s71, 1
    s_cbranch_scc0 LW_21
    s_mov_b32 s71, 0
LD_22:
    s_waitcnt vmcnt(0)
    s_mov_b64 exec, 0xff
    buffer_atomic_add v24, v4, s[32:35], s58 offen sc1
    s_mov_b64 exec, -1
F_ATT:
    s_setprio 3
    s_mul_i32 s62, s28, 672
    v_lshlrev_b32 v22, 4, v1
    v_add_u32 v22, s62, v22
    s_add_u32 s62, s62, 116736
    s_mov_b32 s64, -1
    s_mov_b32 s65, 0x3ff
    s_mov_b32 s63, 21504
    v_and_b32 v2, 31, v1
    v_lshrrev_b32 v3, 5, v1
    s_and_b32 s66, s28, 3
    s_lshr_b32 s67, s28, 2
    s_mul_i32 s56, s67, 2688
    s_add_u32 s56, s56, 116736
    v_lshlrev_b32 v19, 4, v1
    v_add_u32 v19, s56, v19
    v_lshlrev_b32 v20, 3, v2
    v_add_u32 v20, 1024, v20
    v_add_u32 v20, s56, v20
    v_min_u32 v4, 21, v2
    v_mul_u32_u24 v5, 22, v3
    v_add_u32 v4, v4, v5
    v_lshlrev_b32 v21, 4, v4
    v_add_u32 v21, 1280, v21
    v_add_u32 v21, s56, v21
    v_mov_b32 v18, 0xdddddddd
    v_mov_b32 v136, 0
    v_mov_b32 v137, 0
    v_mov_b32 v138, 0
    v_mov_b32 v139, 0
    v_mov_b32 v140, 0
    v_mov_b32 v141, 0
    v_mov_b32 v142, 0
    v_mov_b32 v143, 0
    v_mov_b32 v144, 0
    v_mov_b32 v145, 0
    v_mov_b32 v146, 0
    v_mov_b32 v147, 0
    v_mov_b32 v148, 0
    v_mov_b32 v149, 0
    v_mov_b32 v150, 0
    v_mov_b32 v151, 0
    v_mov_b32 v152, 0
    v_mov_b32 v153, 0
    v_mov_b32 v154, 0
    v_mov_b32 v155, 0
    v_mov_b32 v156, 0
    v_mov_b32 v157, 0
    v_mov_b32 v158, 0
    v_mov_b32 v159, 0
    v_mov_b32 v160, 0
    v_mov_b32 v161, 0
    v_mov_b32 v162, 0
    v_mov_b32 v163, 0
    v_mov_b32 v164, 0
    v_mov_b32 v165, 0
    v_mov_b32 v166, 0
    v_mov_b32 v167, 0
    v_mov_b32 v128, 0
    v_mov_b32 v129, 0
    v_mov_b32 v130, 0
    v_mov_b32 v131, 0
    v_mov_b32 v132, 0
    v_mov_b32 v133, 0
    v_mov_b32 v134, 0
    v_mov_b32 v135, 0
    v_mov_b32 v36, 0
    v_mov_b32 v37, 0
    v_mov_b32 v38, 0
    v_mov_b32 v39, 0
    s_mul_i32 s56, s66, 3072
    s_add_u32 s56, s56, 81920
    v_mul_u32_u24 v4, 48, v2
    v_add_u32 v4, s56, v4
    v_lshl_add_u32 v5, v3, 4, v4
    v_mul_u32_u24 v74, 1536, v3
    v_add_u32 v4, v4, v74
LW_23:
    ds_read_b32 v25, v23 offset:48
    s_waitcnt lgkmcnt(0)
    v_readfirstlane_b32 s70, v25
    s_cmp_ge_u32 s70, 1
    s_cbranch_scc1 LD_24
    s_sleep 2
    s_sub_u32 s71, s71, 1
    s_cbranch_scc0 LW_23
    s_mov_b32 s71, 0
LD_24:
    ds_read_b128 v[28:31], v19 offset:21504
    ds_read_b64 v[26:27], v20 offset:21504
    ds_read_b128 v[32:35], v21 offset:21504
    ds_read_b32 v72, v23 offset:124
LW_25:
    ds_read_b32 v25, v23 offset:44
    s_waitcnt lgkmcnt(0)
    v_readfirstlane_b32 s70, v25
    s_cmp_ge_u32 s70, 4
    s_cbranch_scc1 LD_26
    s_sleep 1
    s_sub_u32 s71, s71, 1
    s_cbranch_scc0 LW_25
    s_mov_b32 s71, 0
LD_26:
    ds_read_b128 v[8:11], v5
    ds_read_b128 v[12:15], v5 offset:1536
    ds_read_b64 v[16:17], v4 offset:32
    s_mov_b64 exec, s[64:65]
    s_add_u32 m0, s62, 0
    s_nop 0
    buffer_load_dwordx4 v22, s[32:35], s63 offen sc1 lds
    s_add_u32 s63, s63, 5376
    s_add_u32 m0, s62, 5376
    s_nop 0
    buffer_load_dwordx4 v22, s[32:35], s63 offen sc1 lds
    s_add_u32 s63, s63, 5376
    s_add_u32 m0, s62, 10752
    s_nop 0
    buffer_load_dwordx4 v22, s[32:35], s63 offen sc1 lds
    s_add_u32 s63, s63, 5376
    s_mov_b64 exec, -1
    v_mov_b32 v4, 0
    v_mov_b32 v5, 0
    v_mov_b32 v6, 0
    s_waitcnt lgkmcnt(0)
    s_mov_b64 exec, 1
    ds_add_u32 v23, v24 offset:60
    s_mov_b64 exec, -1
    v_dot2_f32_bf16 v4, v8, v8, v4
    v_dot2_f32_bf16 v5, v12, v12, v5
    v_dot2_f32_bf16 v4, v9, v9, v4
    v_dot2_f32_bf16 v5, v13, v13, v5
    v_dot2_f32_bf16 v4, v10, v10, v4
    v_dot2_f32_bf16 v5, v14, v14, v5
    v_dot2_f32_bf16 v4, v11, v11, v4
    v_dot2_f32_bf16 v5, v15, v15, v5
    v_dot2_f32_bf16 v6, v16, v16, v6
    v_dot2_f32_bf16 v6, v17, v17, v6
    v_cmp_eq_u32 vcc, 0, v3
    s_nop 1
    v_cndmask_b32 v7, 0, v6, vcc
    v_sub_f32 v6, v6, v7
    v_add_f32 v4, v4, v7
    v_add_f32 v5, v5, v6
    v_mov_b32 v6, v4
    v_mov_b32 v7, v5
    s_nop 1
    v_permlane32_swap_b32 v4, v6
    v_permlane32_swap_b32 v5, v7
    s_nop 1
    v_add_f32 v4, v4, v6
    v_add_f32 v5, v5, v7
    v_mul_f32 v4, v4, v72
    v_mul_f32 v5, v5, v72
    v_sqrt_f32 v4, v4
    v_sqrt_f32 v5, v5
    s_nop 0
    v_mul_f32 v4, 0xbf802000, v4
    v_mul_f32 v5, 0xbf802000, v5
    v_mov_b32 v40, v4
    v_mov_b32 v41, v4
    v_mov_b32 v42, v4
    v_mov_b32 v43, v4
    v_mov_b32 v44, v4
    v_mov_b32 v45, v4
    v_mov_b32 v46, v4
    v_mov_b32 v47, v4
    v_mov_b32 v48, v4
    v_mov_b32 v49, v4
    v_mov_b32 v50, v4
    v_mov_b32 v51, v4
    v_mov_b32 v52, v4
    v_mov_b32 v53, v4
    v_mov_b32 v54, v4
    v_mov_b32 v55, v4
    v_mov_b32 v56, v5
    v_mov_b32 v57, v5
    v_mov_b32 v58, v5
    v_mov_b32 v59, v5
    v_mov_b32 v60, v5
    v_mov_b32 v61, v5
    v_mov_b32 v62, v5
    v_mov_b32 v63, v5
    v_mov_b32 v64, v5
    v_mov_b32 v65, v5
    v_mov_b32 v66, v5
    v_mov_b32 v67, v5
    v_mov_b32 v68, v5
    v_mov_b32 v69, v5
    v_mov_b32 v70, v5
    v_mov_b32 v71, v5
    v_mfma_f32_32x32x16_bf16 v[72:87], v[28:31], v[8:11], v[40:55]
    s_nop 0
    v_mfma_f32_32x32x16_bf16 v[88:103], v[28:31], v[12:15], v[56:71]
    s_nop 9
    v_mfma_f32_32x32x4_2b_bf16 v[72:103], v[26:27], v[16:17], v[72:103]
    s_nop 3
    ds_read_b128 v[28:31], v19 offset:26880
    ds_read_b64 v[26:27], v20 offset:26880
    s_mov_b32 s56, 0
    s_mov_b32 s57, 8
    s_mov_b32 s58, 16
    s_setprio 1
    s_waitcnt lgkmcnt(0)
    s_nop 12
.p2align 6
F_LOOP:
    v_exp_f32 v72, v72
    v_exp_f32 v73, v73
    v_smfmac_f32_32x32x32_bf16 v[152:167], v[36:39], v[128:135], v18
    ds_read_b128 v[36:39], v21 offset:22208
    v_exp_f32 v74, v74
    v_exp_f32 v75, v75
    v_exp_f32 v76, v76
    v_mfma_f32_32x32x16_bf16 v[104:119], v[28:31], v[8:11], v[40:55]
    v_exp_f32 v77, v77
    v_exp_f32 v78, v78
    v_exp_f32 v79, v79
    v_exp_f32 v80, v80
    v_mfma_f32_32x32x16_bf16 v[120:135], v[28:31], v[12:15], v[56:71]
    ds_read_b128 v[28:31], v19 offset:32256
    v_exp_f32 v81, v81
    v_exp_f32 v82, v82
    v_exp_f32 v83, v83
    v_exp_f32 v84, v84
    s_waitcnt lgkmcnt(3)
    v_smfmac_f32_32x32x32_bf16 v[136:151], v[32:35], v[72:79], v18
    v_exp_f32 v85, v85
    v_exp_f32 v86, v86
    v_exp_f32 v87, v87
    v_exp_f32 v88, v88
    v_mfma_f32_32x32x4_2b_bf16 v[104:135], v[26:27], v[16:17], v[104:135]
    ds_read_b64 v[26:27], v20 offset:32256
    v_exp_f32 v89, v89
    v_exp_f32 v90, v90
    v_exp_f32 v91, v91
    v_exp_f32 v92, v92
    v_exp_f32 v93, v93
    v_exp_f32 v94, v94
    v_exp_f32 v95, v95
    s_waitcnt lgkmcnt(2)
    v_smfmac_f32_32x32x32_bf16 v[136:151], v[36:39], v[80:87], v18
    ds_read_b32 v25, v23 offset:76
    v_exp_f32 v96, v96
    v_exp_f32 v97, v97
    v_exp_f32 v98, v98
    v_exp_f32 v99, v99
    v_smfmac_f32_32x32x32_bf16 v[152:167], v[32:35], v[88:95], v18
    ds_read_b128 v[32:35], v21 offset:26880
    v_exp_f32 v100, v100
    v_exp_f32 v101, v101
    v_exp_f32 v102, v102
    v_exp_f32 v103, v103
    s_waitcnt vmcnt(2) lgkmcnt(1)
    v_readfirstlane_b32 s70, v25
    s_mov_b64 exec, 1
    ds_add_u32 v23, v24 offset:64
    s_cmp_ge_u32 s70, s56
    s_cbranch_scc0 F_SP_27
F_BK_28:
    s_mov_b64 exec, s[64:65]
    s_add_u32 m0, s62, 16128
    s_nop 0
    buffer_load_dwordx4 v22, s[32:35], s63 offen sc1 lds
    s_add_u32 s63, s63, 5376
    s_mov_b64 exec, -1
    s_cmp_eq_u32 s56, 48
    s_cselect_b32 s69, 0x10000, 0
    s_add_u32 s62, s62, s69
    s_nop 0
    v_exp_f32 v104, v104
    v_exp_f32 v105, v105
    v_smfmac_f32_32x32x32_bf16 v[152:167], v[36:39], v[96:103], v18
    ds_read_b128 v[36:39], v21 offset:27584
    v_exp_f32 v106, v106
    v_exp_f32 v107, v107
    v_exp_f32 v108, v108
    v_mfma_f32_32x32x16_bf16 v[72:87], v[28:31], v[8:11], v[40:55]
    v_exp_f32 v109, v109
    v_exp_f32 v110, v110
    v_exp_f32 v111, v111
    v_exp_f32 v112, v112
    v_mfma_f32_32x32x16_bf16 v[88:103], v[28:31], v[12:15], v[56:71]
    ds_read_b128 v[28:31], v19 offset:37632
    v_exp_f32 v113, v113
    v_exp_f32 v114, v114
    v_exp_f32 v115, v115
    v_exp_f32 v116, v116
    s_waitcnt lgkmcnt(3)
    v_smfmac_f32_32x32x32_bf16 v[136:151], v[32:35], v[104:111], v18
    v_exp_f32 v117, v117
    v_exp_f32 v118, v118
    v_exp_f32 v119, v119
    v_exp_f32 v120, v120
    v_mfma_f32_32x32x4_2b_bf16 v[72:103], v[26:27], v[16:17], v[72:103]
    ds_read_b64 v[26:27], v20 offset:37632
    v_exp_f32 v121, v121
    v_exp_f32 v122, v122
    v_exp_f32 v123, v123
    v_exp_f32 v124, v124
    v_exp_f32 v125, v125
    v_exp_f32 v126, v126
    v_exp_f32 v127, v127
    s_waitcnt lgkmcnt(2)
    v_smfmac_f32_32x32x32_bf16 v[136:151], v[36:39], v[112:119], v18
    ds_read_b32 v25, v23 offset:64
    v_exp_f32 v128, v128
    v_exp_f32 v129, v129
    v_exp_f32 v130, v130
    v_exp_f32 v131, v131
    v_smfmac_f32_32x32x32_bf16 v[152:167], v[32:35], v[120:127], v18
    ds_read_b128 v[32:35], v21 offset:32256
    v_exp_f32 v132, v132
    v_exp_f32 v133, v133
    v_exp_f32 v134, v134
    v_exp_f32 v135, v135
    s_waitcnt vmcnt(2) lgkmcnt(1)
    v_readfirstlane_b32 s70, v25
    s_mov_b64 exec, 1
    ds_add_u32 v23, v24 offset:68
    s_cmp_ge_u32 s70, s57
    s_cbranch_scc0 F_SP_29
F_BK_30:
    s_mov_b64 exec, s[64:65]
    s_add_u32 m0, s62, 21504
    s_nop 0
    buffer_load_dwordx4 v22, s[32:35], s63 offen sc1 lds
    s_add_u32 s63, s63, 5376
    s_mov_b64 exec, -1
    v_exp_f32 v72, v72
    v_exp_f32 v73, v73
    v_smfmac_f32_32x32x32_bf16 v[152:167], v[36:39], v[128:135], v18
    ds_read_b128 v[36:39], v21 offset:32960
    v_exp_f32 v74, v74
    v_exp_f32 v75, v75
    v_exp_f32 v76, v76
    v_mfma_f32_32x32x16_bf16 v[104:119], v[28:31], v[8:11], v[40:55]
    v_exp_f32 v77, v77
    v_exp_f32 v78, v78
    v_exp_f32 v79, v79
    v_exp_f32 v80, v80
    v_mfma_f32_32x32x16_bf16 v[120:135], v[28:31], v[12:15], v[56:71]
    ds_read_b128 v[28:31], v19 offset:0
    v_exp_f32 v81, v81
    v_exp_f32 v82, v82
    v_exp_f32 v83, v83
    v_exp_f32 v84, v84
    s_waitcnt lgkmcnt(3)
    v_smfmac_f32_32x32x32_bf16 v[136:151], v[32:35], v[72:79], v18
    v_exp_f32 v85, v85
    v_exp_f32 v86, v86
    v_exp_f32 v87, v87
    v_exp_f32 v88, v88
    v_mfma_f32_32x32x4_2b_bf16 v[104:135], v[26:27], v[16:17], v[104:135]
    ds_read_b64 v[26:27], v20 offset:0
    v_exp_f32 v89, v89
    v_exp_f32 v90, v90
    v_exp_f32 v91, v91
    v_exp_f32 v92, v92
    v_exp_f32 v93, v93
    v_exp_f32 v94, v94
    v_exp_f32 v95, v95
    s_waitcnt lgkmcnt(2)
    v_smfmac_f32_32x32x32_bf16 v[136:151], v[36:39], v[80:87], v18
    ds_read_b32 v25, v23 offset:68
    v_exp_f32 v96, v96
    v_exp_f32 v97, v97
    v_exp_f32 v98, v98
    v_exp_f32 v99, v99
    v_smfmac_f32_32x32x32_bf16 v[152:167], v[32:35], v[88:95], v18
    ds_read_b128 v[32:35], v21 offset:37632
    v_exp_f32 v100, v100
    v_exp_f32 v101, v101
    v_exp_f32 v102, v102
    v_exp_f32 v103, v103
    s_waitcnt vmcnt(2) lgkmcnt(1)
    v_readfirstlane_b32 s70, v25
    s_mov_b64 exec, 1
    ds_add_u32 v23, v24 offset:72
    s_cmp_ge_u32 s70, s57
    s_cbranch_scc0 F_SP_31
F_BK_32:
    s_mov_b64 exec, s[64:65]
    s_add_u32 m0, s62, 26880
    s_nop 0
    buffer_load_dwordx4 v22, s[32:35], s63 offen sc1 lds
    s_add_u32 s63, s63, 5376
    s_mov_b64 exec, -1
    v_exp_f32 v104, v104
    v_exp_f32 v105, v105
    v_smfmac_f32_32x32x32_bf16 v[152:167], v[36:39], v[96:103], v18
    ds_read_b128 v[36:39], v21 offset:38336
    v_exp_f32 v106, v106
    v_exp_f32 v107, v107
    v_exp_f32 v108, v108
    v_mfma_f32_32x32x16_bf16 v[72:87], v[28:31], v[8:11], v[40:55]
    v_exp_f32 v109, v109
    v_exp_f32 v110, v110
    v_exp_f32 v111, v111
    v_exp_f32 v112, v112
    v_mfma_f32_32x32x16_bf16 v[88:103], v[28:31], v[12:15], v[56:71]
    ds_read_b128 v[28:31], v19 offset:5376
    v_exp_f32 v113, v113
    v_exp_f32 v114, v114
    v_exp_f32 v115, v115
    v_exp_f32 v116, v116
    s_waitcnt lgkmcnt(3)
    v_smfmac_f32_32x32x32_bf16 v[136:151], v[32:35], v[104:111], v18
    v_exp_f32 v117, v117
    v_exp_f32 v118, v118
    v_exp_f32 v119, v119
    v_exp_f32 v120, v120
    v_mfma_f32_32x32x4_2b_bf16 v[72:103], v[26:27], v[16:17], v[72:103]
    ds_read_b64 v[26:27], v20 offset:5376
    v_exp_f32 v121, v121
    v_exp_f32 v122, v122
    v_exp_f32 v123, v123
    v_exp_f32 v124, v124
    v_exp_f32 v125, v125
    v_exp_f32 v126, v126
    v_exp_f32 v127, v127
    s_waitcnt lgkmcnt(2)
    v_smfmac_f32_32x32x32_bf16 v[136:151], v[36:39], v[112:119], v18
    ds_read_b32 v25, v23 offset:72
    v_exp_f32 v128, v128
    v_exp_f32 v129, v129
    v_exp_f32 v130, v130
    v_exp_f32 v131, v131
    v_smfmac_f32_32x32x32_bf16 v[152:167], v[32:35], v[120:127], v18
    ds_read_b128 v[32:35], v21 offset:0
    v_exp_f32 v132, v132
    v_exp_f32 v133, v133
    v_exp_f32 v134, v134
    v_exp_f32 v135, v135
    s_waitcnt vmcnt(2) lgkmcnt(1)
    v_readfirstlane_b32 s70, v25
    s_mov_b64 exec, 1
    ds_add_u32 v23, v24 offset:76
    s_cmp_ge_u32 s70, s57
    s_cbranch_scc0 F_SP_33
F_BK_34:
    s_mov_b64 exec, s[64:65]
    s_add_u32 m0, s62, 32256
    s_nop 0
    buffer_load_dwordx4 v22, s[32:35], s63 offen sc1 lds
    s_add_u32 s63, s63, 5376
    s_mov_b64 exec, -1
    v_exp_f32 v72, v72
    v_exp_f32 v73, v73
    v_smfmac_f32_32x32x32_bf16 v[152:167], v[36:39], v[128:135], v18
    ds_read_b128 v[36:39], v21 offset:704
    v_exp_f32 v74, v74
    v_exp_f32 v75, v75
    v_exp_f32 v76, v76
    v_mfma_f32_32x32x16_bf16 v[104:119], v[28:31], v[8:11], v[40:55]
    v_exp_f32 v77, v77
    v_exp_f32 v78, v78
    v_exp_f32 v79, v79
    v_exp_f32 v80, v80
    v_mfma_f32_32x32x16_bf16 v[120:135], v[28:31], v[12:15], v[56:71]
    ds_read_b128 v[28:31], v19 offset:10752
    v_exp_f32 v81, v81
    v_exp_f32 v82, v82
    v_exp_f32 v83, v83
    v_exp_f32 v84, v84
    s_waitcnt lgkmcnt(3)
    v_smfmac_f32_32x32x32_bf16 v[136:151], v[32:35], v[72:79], v18
    v_exp_f32 v85, v85
    v_exp_f32 v86, v86
    v_exp_f32 v87, v87
    v_exp_f32 v88, v88
    v_mfma_f32_32x32x4_2b_bf16 v[104:135], v[26:27], v[16:17], v[104:135]
    ds_read_b64 v[26:27], v20 offset:10752
    v_exp_f32 v89, v89
    v_exp_f32 v90, v90
    v_exp_f32 v91, v91
    v_exp_f32 v92, v92
    v_exp_f32 v93, v93
    v_exp_f32 v94, v94
    v_exp_f32 v95, v95
    s_waitcnt lgkmcnt(2)
    v_smfmac_f32_32x32x32_bf16 v[136:151], v[36:39], v[80:87], v18
    ds_read_b32 v25, v23 offset:76
    v_exp_f32 v96, v96
    v_exp_f32 v97, v97
    v_exp_f32 v98, v98
    v_exp_f32 v99, v99
    v_smfmac_f32_32x32x32_bf16 v[152:167], v[32:35], v[88:95], v18
    ds_read_b128 v[32:35], v21 offset:5376
    v_exp_f32 v100, v100
    v_exp_f32 v101, v101
    v_exp_f32 v102, v102
    v_exp_f32 v103, v103
    s_waitcnt vmcnt(2) lgkmcnt(1)
    v_readfirstlane_b32 s70, v25
    s_mov_b64 exec, 1
    ds_add_u32 v23, v24 offset:64
    s_cmp_ge_u32 s70, s57
    s_cbranch_scc0 F_SP_35
F_BK_36:
    s_mov_b64 exec, s[64:65]
    s_add_u32 m0, s62, 37632
    s_nop 0
    buffer_load_dwordx4 v22, s[32:35], s63 offen sc1 lds
    s_add_u32 s63, s63, 5376
    s_mov_b64 exec, -1
    v_exp_f32 v104, v104
    v_exp_f32 v105, v105
    v_smfmac_f32_32x32x32_bf16 v[152:167], v[36:39], v[96:103], v18
    ds_read_b128 v[36:39], v21 offset:6080
    v_exp_f32 v106, v106
    v_exp_f32 v107, v107
    v_exp_f32 v108, v108
    v_mfma_f32_32x32x16_bf16 v[72:87], v[28:31], v[8:11], v[40:55]
    v_exp_f32 v109, v109
    v_exp_f32 v110, v110
    v_exp_f32 v111, v111
    v_exp_f32 v112, v112
    v_mfma_f32_32x32x16_bf16 v[88:103], v[28:31], v[12:15], v[56:71]
    ds_read_b128 v[28:31], v19 offset:16128
    v_exp_f32 v113, v113
    v_exp_f32 v114, v114
    v_exp_f32 v115, v115
    v_exp_f32 v116, v116
    s_waitcnt lgkmcnt(3)
    v_smfmac_f32_32x32x32_bf16 v[136:151], v[32:35], v[104:111], v18
    v_exp_f32 v117, v117
    v_exp_f32 v118, v118
    v_exp_f32 v119, v119
    v_exp_f32 v120, v120
    v_mfma_f32_32x32x4_2b_bf16 v[72:103], v[26:27], v[16:17], v[72:103]
    ds_read_b64 v[26:27], v20 offset:16128
    v_exp_f32 v121, v121
    v_exp_f32 v122, v122
    v_exp_f32 v123, v123
    v_exp_f32 v124, v124
    v_exp_f32 v125, v125
    v_exp_f32 v126, v126
    v_exp_f32 v127, v127
    s_waitcnt lgkmcnt(2)
    v_smfmac_f32_32x32x32_bf16 v[136:151], v[36:39], v[112:119], v18
    ds_read_b32 v25, v23 offset:64
    v_exp_f32 v128, v128
    v_exp_f32 v129, v129
    v_exp_f32 v130, v130
    v_exp_f32 v131, v131
    v_smfmac_f32_32x32x32_bf16 v[152:167], v[32:35], v[120:127], v18
    ds_read_b128 v[32:35], v21 offset:10752
    v_exp_f32 v132, v132
    v_exp_f32 v133, v133
    v_exp_f32 v134, v134
    v_exp_f32 v135, v135
    s_waitcnt vmcnt(2) lgkmcnt(1)
    v_readfirstlane_b32 s70, v25
    s_mov_b64 exec, 1
    ds_add_u32 v23, v24 offset:68
    s_cmp_ge_u32 s70, s58
    s_cbranch_scc0 F_SP_37
F_BK_38:
    s_mov_b64 exec, s[64:65]
    s_add_u32 m0, s62, 0
    s_nop 0
    buffer_load_dwordx4 v22, s[32:35], s63 offen sc1 lds
    s_add_u32 s63, s63, 5376
    s_mov_b64 exec, -1
    v_exp_f32 v72, v72
    v_exp_f32 v73, v73
    v_smfmac_f32_32x32x32_bf16 v[152:167], v[36:39], v[128:135], v18
    ds_read_b128 v[36:39], v21 offset:11456
    v_exp_f32 v74, v74
    v_exp_f32 v75, v75
    v_exp_f32 v76, v76
    v_mfma_f32_32x32x16_bf16 v[104:119], v[28:31], v[8:11], v[40:55]
    v_exp_f32 v77, v77
    v_exp_f32 v78, v78
    v_exp_f32 v79, v79
    v_exp_f32 v80, v80
    v_mfma_f32_32x32x16_bf16 v[120:135], v[28:31], v[12:15], v[56:71]
    ds_read_b128 v[28:31], v19 offset:21504
    v_exp_f32 v81, v81
    v_exp_f32 v82, v82
    v_exp_f32 v83, v83
    v_exp_f32 v84, v84
    s_waitcnt lgkmcnt(3)
    v_smfmac_f32_32x32x32_bf16 v[136:151], v[32:35], v[72:79], v18
    v_exp_f32 v85, v85
    v_exp_f32 v86, v86
    v_exp_f32 v87, v87
    v_exp_f32 v88, v88
    v_mfma_f32_32x32x4_2b_bf16 v[104:135], v[26:27], v[16:17], v[104:135]
    ds_read_b64 v[26:27], v20 offset:21504
    v_exp_f32 v89, v89
    v_exp_f32 v90, v90
    v_exp_f32 v91, v91
    v_exp_f32 v92, v92
    v_exp_f32 v93, v93
    v_exp_f32 v94, v94
    v_exp_f32 v95, v95
    s_waitcnt lgkmcnt(2)
    v_smfmac_f32_32x32x32_bf16 v[136:151], v[36:39], v[80:87], v18
    ds_read_b32 v25, v23 offset:68
    v_exp_f32 v96, v96
    v_exp_f32 v97, v97
    v_exp_f32 v98, v98
    v_exp_f32 v99, v99
    v_smfmac_f32_32x32x32_bf16 v[152:167], v[32:35], v[88:95], v18
    ds_read_b128 v[32:35], v21 offset:16128
    v_exp_f32 v100, v100
    v_exp_f32 v101, v101
    v_exp_f32 v102, v102
    v_exp_f32 v103, v103
    s_waitcnt vmcnt(2) lgkmcnt(1)
    v_readfirstlane_b32 s70, v25
    s_mov_b64 exec, 1
    ds_add_u32 v23, v24 offset:72
    s_cmp_ge_u32 s70, s58
    s_cbranch_scc0 F_SP_39
F_BK_40:
    s_mov_b64 exec, s[64:65]
    s_add_u32 m0, s62, 5376
    s_nop 0
    buffer_load_dwordx4 v22, s[32:35], s63 offen sc1 lds
    s_add_u32 s63, s63, 5376
    s_mov_b64 exec, -1
    v_exp_f32 v104, v104
    v_exp_f32 v105, v105
    v_smfmac_f32_32x32x32_bf16 v[152:167], v[36:39], v[96:103], v18
    ds_read_b128 v[36:39], v21 offset:16832
    v_exp_f32 v106, v106
    v_exp_f32 v107, v107
    v_exp_f32 v108, v108
    v_mfma_f32_32x32x16_bf16 v[72:87], v[28:31], v[8:11], v[40:55]
    v_exp_f32 v109, v109
    v_exp_f32 v110, v110
    v_exp_f32 v111, v111
    v_exp_f32 v112, v112
    v_mfma_f32_32x32x16_bf16 v[88:103], v[28:31], v[12:15], v[56:71]
    ds_read_b128 v[28:31], v19 offset:26880
    v_exp_f32 v113, v113
    v_exp_f32 v114, v114
    v_exp_f32 v115, v115
    v_exp_f32 v116, v116
    s_waitcnt lgkmcnt(3)
    v_smfmac_f32_32x32x32_bf16 v[136:151], v[32:35], v[104:111], v18
    v_exp_f32 v117, v117
    v_exp_f32 v118, v118
    v_exp_f32 v119, v119
    v_exp_f32 v120, v120
    v_mfma_f32_32x32x4_2b_bf16 v[72:103], v[26:27], v[16:17], v[72:103]
    ds_read_b64 v[26:27], v20 offset:26880
    v_exp_f32 v121, v121
    v_exp_f32 v122, v122
    v_exp_f32 v123, v123
    v_exp_f32 v124, v124
    v_exp_f32 v125, v125
    v_exp_f32 v126, v126
    v_exp_f32 v127, v127
    s_waitcnt lgkmcnt(2)
    v_smfmac_f32_32x32x32_bf16 v[136:151], v[36:39], v[112:119], v18
    ds_read_b32 v25, v23 offset:72
    v_exp_f32 v128, v128
    v_exp_f32 v129, v129
    v_exp_f32 v130, v130
    v_exp_f32 v131, v131
    v_smfmac_f32_32x32x32_bf16 v[152:167], v[32:35], v[120:127], v18
    ds_read_b128 v[32:35], v21 offset:21504
    v_exp_f32 v132, v132
    v_exp_f32 v133, v133
    v_exp_f32 v134, v134
    v_exp_f32 v135, v135
    s_waitcnt vmcnt(2) lgkmcnt(1)
    v_readfirstlane_b32 s70, v25
    s_mov_b64 exec, 1
    ds_add_u32 v23, v24 offset:76
    s_cmp_ge_u32 s70, s58
    s_cbranch_scc0 F_SP_41
F_BK_42:
    s_mov_b64 exec, s[64:65]
    s_add_u32 m0, s62, 10752
    s_nop 0
    buffer_load_dwordx4 v22, s[32:35], s63 offen sc1 lds
    s_add_u32 s63, s63, 5376
    s_mov_b64 exec, -1
    s_add_u32 s56, s56, 16
    s_add_u32 s57, s57, 16
    s_add_u32 s58, s58, 16
    s_cmp_lt_u32 s56, 64
    s_cbranch_scc1 F_LOOP
    s_waitcnt lgkmcnt(0)
    v_smfmac_f32_32x32x32_bf16 v[152:167], v[36:39], v[128:135], v18
    s_setprio 3
    s_mul_i32 s56, s66, 3072
    s_add_u32 s56, s56, 116736
    s_add_u32 s58, s56, 21504
    s_cmp_eq_u32 s67, 0
    s_cselect_b32 s59, s58, s56
    s_cselect_b32 s58, s56, s58
    v_lshlrev_b32 v7, 4, v1
    v_add_u32 v4, s59, v7
    s_xor_b32 s57, s28, 4
    v_add_u32 v5, s58, v7
    s_lshl_b32 s59, s67, 5
    v_add_u32 v6, s59, v2
    v_lshlrev_b32 v7, 2, v6
    v_add_u32 v7, 163584, v7
    s_cmp_eq_u32 s67, 0
    s_cbranch_scc1 F_X0
    ds_write_b128 v4, v[136:139] offset:0
    ds_write_b128 v4, v[140:143] offset:1024
    ds_write_b128 v4, v[144:147] offset:2048
    v_mov_b32 v88, v152
    v_mov_b32 v89, v153
    v_mov_b32 v90, v154
    v_mov_b32 v91, v155
    v_mov_b32 v92, v156
    v_mov_b32 v93, v157
    v_mov_b32 v94, v158
    v_mov_b32 v95, v159
    v_mov_b32 v96, v160
    v_mov_b32 v97, v161
    v_mov_b32 v98, v162
    v_mov_b32 v99, v163
    s_branch F_X1
F_X0:
    ds_write_b128 v4, v[152:155] offset:0
    ds_write_b128 v4, v[156:159] offset:1024
    ds_write_b128 v4, v[160:163] offset:2048
    v_mov_b32 v88, v136
    v_mov_b32 v89, v137
    v_mov_b32 v90, v138
    v_mov_b32 v91, v139
    v_mov_b32 v92, v140
    v_mov_b32 v93, v141
    v_mov_b32 v94, v142
    v_mov_b32 v95, v143
    v_mov_b32 v96, v144
    v_mov_b32 v97, v145
    v_mov_b32 v98, v146
    v_mov_b32 v99, v147
F_X1:
    s_lshl_b32 s56, s28, 2
    s_lshl_b32 s57, s57, 2
    v_add_u32 v28, s56, v23
    v_add_u32 v29, s57, v23
    s_waitcnt lgkmcnt(0)
    s_mov_b64 exec, 1
    ds_add_u32 v28, v24 offset:80
    s_mov_b64 exec, -1
LW_43:
    ds_read_b32 v25, v23 offset:52
    s_waitcnt lgkmcnt(0)
    v_readfirstlane_b32 s70, v25
    s_cmp_ge_u32 s70, 4
    s_cbranch_scc1 LD_44
    s_sleep 2
    s_sub_u32 s71, s71, 1
    s_cbranch_scc0 LW_43
    s_mov_b32 s71, 0
LD_44:
    ds_read_b32 v72, v7
F_XW:
    ds_read_b32 v25, v29 offset:80
    s_waitcnt lgkmcnt(0)
    v_readfirstlane_b32 s70, v25
    s_cmp_ge_u32 s70, 1
    s_cbranch_scc1 F_XD
    s_sleep 1
    s_sub_u32 s71, s71, 1
    s_cbranch_scc0 F_XW
    s_mov_b32 s71, 0
F_XD:
    ds_read_b128 v[136:139], v5 offset:0
    ds_read_b128 v[140:143], v5 offset:1024
    ds_read_b128 v[144:147], v5 offset:2048
    s_waitcnt lgkmcnt(0)
    v_pk_add_f32 v[88:89], v[88:89], v[136:137]
    v_pk_add_f32 v[90:91], v[90:91], v[138:139]
    v_pk_add_f32 v[92:93], v[92:93], v[140:141]
    v_pk_add_f32 v[94:95], v[94:95], v[142:143]
    v_pk_add_f32 v[96:97], v[96:97], v[144:145]
    v_pk_add_f32 v[98:99], v[98:99], v[146:147]
    v_mov_b32 v4, v96
    v_mov_b32 v5, v96
    s_nop 1
    v_permlane32_swap_b32 v4, v5
    s_nop 1
    v_cmp_le_f32 vcc, 0x21800000, v5
    s_nop 3
    s_cmp_eq_u64 vcc, -1
    s_cbranch_scc0 F_FALLBACK
F_FIN2:
    v_rcp_f32 v5, v5
    v_sub_f32 v72, 1.0, v72
    s_lshl_b32 s56, s30, 2
    s_add_u32 s56, s56, s66
    s_lshr_b32 s57, s56, 1
    s_mul_i32 s57, s57, 5
    s_and_b32 s58, s56, 1
    s_lshl_b32 s59, s58, 1
    s_add_u32 s59, s59, s57
    v_mul_f32 v5, v5, v72
    v_add_u32 v28, s59, v3
    v_lshrrev_b32 v29, 4, v6
    v_mul_u32_u24 v29, 20, v29
    v_and_b32 v30, 15, v6
    v_lshrrev_b32 v31, 2, v28
    v_add_u32 v31, v31, v29
    v_and_b32 v28, 3, v28
    v_lshl_add_u32 v28, v28, 4, v30
    v_lshl_add_u32 v28, v31, 6, v28
    v_lshlrev_b32 v28, 4, v28
    s_add_u32 s57, s57, 4
    s_lshr_b32 s59, s57, 2
    s_and_b32 s57, s57, 3
    s_lshl_b32 s57, s57, 4
    v_add_u32 v31, s59, v29
    v_add_u32 v30, s57, v30
    v_lshl_add_u32 v30, v31, 6, v30
    v_lshlrev_b32 v30, 4, v30
    s_mul_i32 s56, s29, 81920
    s_add_u32 s56, s56, 11141120
    s_lshl_b32 s58, s58, 3
    s_add_u32 s58, s58, s56
    v_pk_mul_f32 v[88:89], v[88:89], v[4:5] op_sel:[0,1] op_sel_hi:[1,1]
    v_pk_mul_f32 v[90:91], v[90:91], v[4:5] op_sel:[0,1] op_sel_hi:[1,1]
    v_pk_mul_f32 v[92:93], v[92:93], v[4:5] op_sel:[0,1] op_sel_hi:[1,1]
    v_pk_mul_f32 v[94:95], v[94:95], v[4:5] op_sel:[0,1] op_sel_hi:[1,1]
    v_pk_mul_f32 v[96:97], v[96:97], v[4:5] op_sel:[0,1] op_sel_hi:[1,1]
    v_pk_mul_f32 v[98:99], v[98:99], v[4:5] op_sel:[0,1] op_sel_hi:[1,1]
    v_cvt_pk_bf16_f32 v104, v88, v89
    v_cvt_pk_bf16_f32 v105, v90, v91
    v_cvt_pk_bf16_f32 v106, v92, v93
    v_cvt_pk_bf16_f32 v107, v94, v95
    v_cvt_pk_bf16_f32 v108, v96, v97
    v_cvt_pk_bf16_f32 v109, v98, v99
    buffer_store_dwordx4 v[104:107], v28, s[32:35], s56 offen sc1
    s_mov_b32 exec_hi, 0
    buffer_store_dwordx2 v[108:109], v30, s[32:35], s58 offen sc1
    s_mov_b64 exec, 1
    s_lshl_b32 s56, s29, 7
    s_add_u32 s56, s56, 3837952
    v_mov_b32 v4, s56
    ds_add_rtn_u32 v25, v23, v24 offset:116
    s_waitcnt lgkmcnt(0)
    v_readfirstlane_b32 s70, v25
    s_cmp_lg_u32 s70, 7
    s_cbranch_scc1 F_AEND
    buffer_atomic_add v24, v4, s[32:35], 0 offen sc1
F_AEND:
    s_mov_b64 exec, -1
    s_mul_i32 s57, s30, 102400
    s_add_u32 s57, s57, 7667712
    s_lshl_b32 s56, s28, 10
    s_add_u32 s57, s57, s56
    v_lshlrev_b32 v4, 4, v1
LW_45:
    ds_read_b32 v25, v23 offset:116
    s_waitcnt lgkmcnt(0)
    v_readfirstlane_b32 s70, v25
    s_cmp_ge_u32 s70, 8
    s_cbranch_scc1 LD_46
    s_sleep 1
    s_sub_u32 s71, s71, 1
    s_cbranch_scc0 LW_45
    s_mov_b32 s71, 0
LD_46:
    s_add_u32 m0, s56, 102400
    s_add_u32 s58, s57, 0
    buffer_load_dwordx4 v4, s[32:35], s58 offen sc1 lds
    s_add_u32 m0, s56, 110592
    s_add_u32 s58, s57, 8192
    buffer_load_dwordx4 v4, s[32:35], s58 offen sc1 lds
    s_add_u32 m0, s56, 118784
    s_add_u32 s58, s57, 16384
    buffer_load_dwordx4 v4, s[32:35], s58 offen sc1 lds
    s_add_u32 m0, s56, 126976
    s_add_u32 s58, s57, 24576
    buffer_load_dwordx4 v4, s[32:35], s58 offen sc1 lds
    s_add_u32 m0, s56, 135168
    s_add_u32 s58, s57, 32768
    buffer_load_dwordx4 v4, s[32:35], s58 offen sc1 lds
    s_add_u32 m0, s56, 143360
    s_add_u32 s58, s57, 40960
    buffer_load_dwordx4 v4, s[32:35], s58 offen sc1 lds
    s_cmp_ge_u32 s28, 2
    s_cbranch_scc1 F_WBS0
    s_add_u32 m0, s56, 151552
    s_add_u32 s58, s57, 49152
    buffer_load_dwordx4 v4, s[32:35], s58 offen sc1 lds
F_WBS0:
LW_47:
    ds_read_b32 v25, v23 offset:184
    s_waitcnt lgkmcnt(0)
    v_readfirstlane_b32 s70, v25
    s_cmp_ge_u32 s70, 4
    s_cbranch_scc1 LD_48
    s_sleep 2
    s_sub_u32 s71, s71, 1
    s_cbranch_scc0 LW_47
    s_mov_b32 s71, 0
LD_48:
    s_add_u32 m0, s56, 0
    s_add_u32 s58, s57, 51200
    buffer_load_dwordx4 v4, s[32:35], s58 offen sc1 lds
    s_add_u32 m0, s56, 8192
    s_add_u32 s58, s57, 59392
    buffer_load_dwordx4 v4, s[32:35], s58 offen sc1 lds
    s_add_u32 m0, s56, 16384
    s_add_u32 s58, s57, 67584
    buffer_load_dwordx4 v4, s[32:35], s58 offen sc1 lds
    s_add_u32 m0, s56, 24576
    s_add_u32 s58, s57, 75776
    buffer_load_dwordx4 v4, s[32:35], s58 offen sc1 lds
    s_add_u32 m0, s56, 32768
    s_add_u32 s58, s57, 83968
    buffer_load_dwordx4 v4, s[32:35], s58 offen sc1 lds
    s_add_u32 m0, s56, 40960
    s_add_u32 s58, s57, 92160
    buffer_load_dwordx4 v4, s[32:35], s58 offen sc1 lds
    s_cmp_ge_u32 s28, 2
    s_cbranch_scc1 F_WBS1
    s_add_u32 m0, s56, 49152
    s_add_u32 s58, s57, 100352
    buffer_load_dwordx4 v4, s[32:35], s58 offen sc1 lds
F_WBS1:
    s_waitcnt vmcnt(0)
    s_mov_b64 exec, 1
    ds_add_u32 v23, v24 offset:188
    s_mov_b64 exec, -1
    s_endpgm
F_SP_27:
    s_mov_b64 exec, -1
    s_sleep 1
    ds_read_b32 v25, v23 offset:76
    s_waitcnt lgkmcnt(0)
    v_readfirstlane_b32 s70, v25
    s_cmp_ge_u32 s70, s56
    s_cbranch_scc1 F_BK_28
    s_sub_u32 s71, s71, 1
    s_cbranch_scc0 F_SP_27
    s_mov_b32 s71, 0
    s_branch F_BK_28
F_SP_29:
    s_mov_b64 exec, -1
    s_sleep 1
    ds_read_b32 v25, v23 offset:64
    s_waitcnt lgkmcnt(0)
    v_readfirstlane_b32 s70, v25
    s_cmp_ge_u32 s70, s57
    s_cbranch_scc1 F_BK_30
    s_sub_u32 s71, s71, 1
    s_cbranch_scc0 F_SP_29
    s_mov_b32 s71, 0
    s_branch F_BK_30
F_SP_31:
    s_mov_b64 exec, -1
    s_sleep 1
    ds_read_b32 v25, v23 offset:68
    s_waitcnt lgkmcnt(0)
    v_readfirstlane_b32 s70, v25
    s_cmp_ge_u32 s70, s57
    s_cbranch_scc1 F_BK_32
    s_sub_u32 s71, s71, 1
    s_cbranch_scc0 F_SP_31
    s_mov_b32 s71, 0
    s_branch F_BK_32
F_SP_33:
    s_mov_b64 exec, -1
    s_sleep 1
    ds_read_b32 v25, v23 offset:72
    s_waitcnt lgkmcnt(0)
    v_readfirstlane_b32 s70, v25
    s_cmp_ge_u32 s70, s57
    s_cbranch_scc1 F_BK_34
    s_sub_u32 s71, s71, 1
    s_cbranch_scc0 F_SP_33
    s_mov_b32 s71, 0
    s_branch F_BK_34
F_SP_35:
    s_mov_b64 exec, -1
    s_sleep 1
    ds_read_b32 v25, v23 offset:76
    s_waitcnt lgkmcnt(0)
    v_readfirstlane_b32 s70, v25
    s_cmp_ge_u32 s70, s57
    s_cbranch_scc1 F_BK_36
    s_sub_u32 s71, s71, 1
    s_cbranch_scc0 F_SP_35
    s_mov_b32 s71, 0
    s_branch F_BK_36
F_SP_37:
    s_mov_b64 exec, -1
    s_sleep 1
    ds_read_b32 v25, v23 offset:64
    s_waitcnt lgkmcnt(0)
    v_readfirstlane_b32 s70, v25
    s_cmp_ge_u32 s70, s58
    s_cbranch_scc1 F_BK_38
    s_sub_u32 s71, s71, 1
    s_cbranch_scc0 F_SP_37
    s_mov_b32 s71, 0
    s_branch F_BK_38
F_SP_39:
    s_mov_b64 exec, -1
    s_sleep 1
    ds_read_b32 v25, v23 offset:68
    s_waitcnt lgkmcnt(0)
    v_readfirstlane_b32 s70, v25
    s_cmp_ge_u32 s70, s58
    s_cbranch_scc1 F_BK_40
    s_sub_u32 s71, s71, 1
    s_cbranch_scc0 F_SP_39
    s_mov_b32 s71, 0
    s_branch F_BK_40
F_SP_41:
    s_mov_b64 exec, -1
    s_sleep 1
    ds_read_b32 v25, v23 offset:72
    s_waitcnt lgkmcnt(0)
    v_readfirstlane_b32 s70, v25
    s_cmp_ge_u32 s70, s58
    s_cbranch_scc1 F_BK_42
    s_sub_u32 s71, s71, 1
    s_cbranch_scc0 F_SP_41
    s_mov_b32 s71, 0
    s_branch F_BK_42
F_G:
    s_setprio 3
    s_sub_u32 s52, s28, 8
    s_lshl_b32 s56, s2, 4
    s_add_u32 s69, s56, s52
    s_cmp_lg_u32 s69, 2
    s_cbranch_scc1 G_NOZ
    v_lshlrev_b32 v2, 7, v1
    v_mov_b32 v3, 0
    s_mov_b32 s56, 3866624
    s_mov_b32 s57, 3874816
    buffer_store_dword v3, v2, s[32:35], s56 offen sc1
    buffer_store_dword v3, v2, s[32:35], s57 offen sc1
G_NOZ:
    s_cmp_lt_u32 s52, 2
    s_cbranch_scc1 G_NOE
    s_cmp_lt_u32 s30, 4
    s_cselect_b32 s40, s14, s16
    s_cselect_b32 s41, s15, s17
    s_mov_b32 s42, 25600
    s_mov_b32 s43, 0x20000
    v_lshlrev_b32 v2, 4, v1
    s_sub_u32 s56, s52, 2
    s_mul_i32 s56, s56, 12288
    s_add_u32 m0, s56, 133120
    s_nop 0
    buffer_load_dwordx4 v2, s[40:43], s56 offen offset:0 lds
    buffer_load_dwordx4 v2, s[40:43], s56 offen offset:1024 lds
    buffer_load_dwordx4 v2, s[40:43], s56 offen offset:2048 lds
    buffer_load_dwordx4 v2, s[40:43], s56 offen offset:3072 lds
    s_add_u32 s56, s56, 4096
    s_barrier
    s_add_u32 m0, s56, 133120
    s_nop 0
    buffer_load_dwordx4 v2, s[40:43], s56 offen offset:0 lds
    buffer_load_dwordx4 v2, s[40:43], s56 offen offset:1024 lds
    buffer_load_dwordx4 v2, s[40:43], s56 offen offset:2048 lds
    buffer_load_dwordx4 v2, s[40:43], s56 offen offset:3072 lds
    s_add_u32 s56, s56, 4096
    s_add_u32 m0, s56, 133120
    s_nop 0
    buffer_load_dwordx4 v2, s[40:43], s56 offen offset:0 lds
    buffer_load_dwordx4 v2, s[40:43], s56 offen offset:1024 lds
    buffer_load_dwordx4 v2, s[40:43], s56 offen offset:2048 lds
    buffer_load_dwordx4 v2, s[40:43], s56 offen offset:3072 lds
    s_add_u32 s56, s56, 4096
    s_add_u32 m0, s56, 133120
    s_nop 0
    buffer_load_dwordx4 v2, s[40:43], s56 offen offset:0 lds
    s_mov_b64 exec, 1
    ds_add_u32 v23, v24 offset:176
    s_mov_b64 exec, -1
    s_branch G_E2
G_NOE:
    s_barrier
G_E2:
    v_and_b32 v14, 15, v1
    v_lshrrev_b32 v15, 4, v1
    v_lshrrev_b32 v8, 1, v14
    v_xor_b32 v8, v8, v15
    v_xor_b32 v9, 4, v8
    s_lshl_b32 s56, s52, 4
    v_add_u32 v10, s56, v14
    v_lshlrev_b32 v10, 7, v10
    v_lshl_add_u32 v2, v8, 4, v10
    v_lshl_add_u32 v3, v9, 4, v10
    s_and_b32 s57, s30, 3
    s_lshl_b32 s57, s57, 4
    v_add_u32 v10, s57, v14
    v_lshlrev_b32 v10, 7, v10
    v_lshl_add_u32 v4, v8, 4, v10
    v_lshl_add_u32 v5, v9, 4, v10
    v_add_u32 v12, 40960, v4
    v_add_u32 v13, 40960, v5
    v_lshrrev_b32 v8, 2, v14
    v_and_b32 v9, 3, v1
    v_lshrrev_b32 v10, 1, v15
    v_and_b32 v11, 1, v15
    v_lshlrev_b32 v10, 4, v10
    v_lshl_add_u32 v10, v11, 2, v10
    v_add_u32 v10, v10, v8
    v_mul_u32_u24 v10, 160, v10
    v_mul_u32_u24 v11, 40, v9
    v_add_u32 v6, v10, v11
    v_add_u32 v6, 81920, v6
    v_lshl_add_u32 v10, v15, 3, v8
    v_mul_u32_u24 v10, 40, v10
    v_lshlrev_b32 v11, 3, v9
    s_cmp_eq_u32 s52, 1
    s_cselect_b64 vcc, -1, 0
    v_mov_b32 v16, 32
    v_add_u32 v10, 133120, v10
    v_cndmask_b32 v11, v11, v16, vcc
    v_add_u32 v7, v10, v11
    v_mov_b32 v16, 163328
    s_lshl_b32 s53, s31, 13
    s_mov_b32 s54, 0
    s_mov_b32 s55, 0
    s_mov_b32 s59, 0
    s_movk_i32 s68, 16384
    s_lshl_b32 s66, s30, 2
    s_add_u32 s66, s66, s52
    s_mov_b32 s60, 1069066811
    s_mov_b32 s61, 1069066811
    s_mov_b32 s62, 1051011932
    s_mov_b32 s63, 1051011932
    v_mov_b32 v26, 0
    v_mov_b32 v27, 0
    v_mov_b32 v28, 0
    v_mov_b32 v29, 0
    v_mov_b32 v30, 0
    v_mov_b32 v31, 0
    v_mov_b32 v32, 0
    v_mov_b32 v33, 0
    v_mov_b32 v34, 0
    v_mov_b32 v35, 0
    v_mov_b32 v36, 0
    v_mov_b32 v37, 0
    v_mov_b32 v38, 0
    v_mov_b32 v39, 0
    v_mov_b32 v40, 0
    v_mov_b32 v41, 0
    v_mov_b32 v42, 0
    v_mov_b32 v43, 0
    v_mov_b32 v44, 0
    v_mov_b32 v45, 0
    s_cmp_lt_u32 s52, 2
    s_cbranch_scc1 G_JOB
    s_waitcnt vmcnt(0)
    s_mov_b64 exec, 1
    ds_add_u32 v23, v24 offset:40
    s_mov_b64 exec, -1
    s_cmp_lg_u32 s69, 2
    s_cbranch_scc1 G_NOZ2
    v_mov_b32 v11, 0
    s_mov_b64 exec, 1
    buffer_store_dword v24, v11, s[48:51], 0 offen sc1
    s_mov_b64 exec, -1
G_NOZ2:
    s_branch G_Q
G_JOB:
LW_49:
    ds_read_b32 v25, v23 offset:40
    s_waitcnt lgkmcnt(0)
    v_readfirstlane_b32 s70, v25
    s_cmp_ge_u32 s70, 4
    s_cbranch_scc1 LD_50
    s_sleep 1
    s_sub_u32 s71, s71, 1
    s_cbranch_scc0 LW_49
    s_mov_b32 s71, 0
LD_50:
    ds_read_b128 v[96:99], v4 offset:0
    ds_read_b64_tr_b16 v[112:113], v7 offset:0
    ds_read_b64_tr_b16 v[114:115], v7 offset:160
    ds_read_b128 v[100:103], v5 offset:0
    ds_read_b64_tr_b16 v[116:117], v7 offset:1280
    ds_read_b64_tr_b16 v[118:119], v7 offset:1440
    ds_read_b128 v[104:107], v4 offset:8192
    ds_read_b64_tr_b16 v[120:121], v7 offset:2560
    ds_read_b64_tr_b16 v[122:123], v7 offset:2720
    ds_read_b128 v[108:111], v5 offset:8192
    ds_read_b64_tr_b16 v[124:125], v7 offset:3840
    ds_read_b64_tr_b16 v[126:127], v7 offset:4000
    s_mov_b32 s59, 1
    s_lshl_b32 s57, s29, 1
    s_bfe_u32 s58, s30, 0x10001
    s_add_u32 s57, s57, s58
    s_mul_i32 s57, s57, 2688
    s_and_b32 s58, s30, 1
    s_cmp_ge_u32 s30, 4
    s_cbranch_scc1 G_JOBV
    s_waitcnt lgkmcnt(9)
    v_mfma_f32_16x16x32_bf16 v[128:131], v[112:115], v[96:99], 0
    ds_read_b128 v[96:99], v4 offset:16384
    ds_read_b64_tr_b16 v[112:113], v7 offset:5120
    ds_read_b64_tr_b16 v[114:115], v7 offset:5280
    s_waitcnt lgkmcnt(9)
    v_mfma_f32_16x16x32_bf16 v[128:131], v[116:119], v[100:103], v[128:131]
    ds_read_b128 v[100:103], v5 offset:16384
    ds_read_b64_tr_b16 v[116:117], v7 offset:6400
    ds_read_b64_tr_b16 v[118:119], v7 offset:6560
    s_waitcnt lgkmcnt(9)
    v_mfma_f32_16x16x32_bf16 v[128:131], v[120:123], v[104:107], v[128:131]
    ds_read_b128 v[104:107], v4 offset:24576
    ds_read_b64_tr_b16 v[120:121], v7 offset:7680
    ds_read_b64_tr_b16 v[122:123], v7 offset:7840
    s_waitcnt lgkmcnt(9)
    v_mfma_f32_16x16x32_bf16 v[128:131], v[124:127], v[108:111], v[128:131]
    ds_read_b128 v[108:111], v5 offset:24576
    ds_read_b64_tr_b16 v[124:125], v7 offset:8960
    ds_read_b64_tr_b16 v[126:127], v7 offset:9120
    s_waitcnt lgkmcnt(9)
    v_mfma_f32_16x16x32_bf16 v[128:131], v[112:115], v[96:99], v[128:131]
    ds_read_b128 v[96:99], v4 offset:32768
    ds_read_b64_tr_b16 v[112:113], v7 offset:10240
    ds_read_b64_tr_b16 v[114:115], v7 offset:10400
    s_waitcnt lgkmcnt(9)
    v_mfma_f32_16x16x32_bf16 v[128:131], v[116:119], v[100:103], v[128:131]
    ds_read_b128 v[100:103], v5 offset:32768
    ds_read_b64_tr_b16 v[116:117], v7 offset:11520
    ds_read_b64_tr_b16 v[118:119], v7 offset:11680
    s_waitcnt lgkmcnt(9)
    v_mfma_f32_16x16x32_bf16 v[128:131], v[120:123], v[104:107], v[128:131]
    ds_read_b128 v[104:107], v12 offset:0
    ds_read_b64_tr_b16 v[120:121], v7 offset:12800
    ds_read_b64_tr_b16 v[122:123], v7 offset:12960
    s_waitcnt lgkmcnt(9)
    v_mfma_f32_16x16x32_bf16 v[128:131], v[124:127], v[108:111], v[128:131]
    ds_read_b128 v[108:111], v13 offset:0
    ds_read_b64_tr_b16 v[124:125], v7 offset:14080
    ds_read_b64_tr_b16 v[126:127], v7 offset:14240
    s_waitcnt lgkmcnt(9)
    v_mfma_f32_16x16x32_bf16 v[128:131], v[112:115], v[96:99], v[128:131]
    ds_read_b128 v[96:99], v12 offset:8192
    ds_read_b64_tr_b16 v[112:113], v7 offset:15360
    ds_read_b64_tr_b16 v[114:115], v7 offset:15520
    s_waitcnt lgkmcnt(9)
    v_mfma_f32_16x16x32_bf16 v[128:131], v[116:119], v[100:103], v[128:131]
    ds_read_b128 v[100:103], v13 offset:8192
    ds_read_b64_tr_b16 v[116:117], v7 offset:16640
    ds_read_b64_tr_b16 v[118:119], v7 offset:16800
    s_waitcnt lgkmcnt(9)
    v_mfma_f32_16x16x32_bf16 v[128:131], v[120:123], v[104:107], v[128:131]
    ds_read_b128 v[104:107], v12 offset:16384
    ds_read_b64_tr_b16 v[120:121], v7 offset:17920
    ds_read_b64_tr_b16 v[122:123], v7 offset:18080
    s_waitcnt lgkmcnt(9)
    v_mfma_f32_16x16x32_bf16 v[128:131], v[124:127], v[108:111], v[128:131]
    ds_read_b128 v[108:111], v13 offset:16384
    ds_read_b64_tr_b16 v[124:125], v7 offset:19200
    ds_read_b64_tr_b16 v[126:127], v7 offset:19360
    s_waitcnt lgkmcnt(9)
    v_mfma_f32_16x16x32_bf16 v[128:131], v[112:115], v[96:99], v[128:131]
    ds_read_b128 v[96:99], v12 offset:24576
    ds_read_b64_tr_b16 v[112:113], v7 offset:20480
    ds_read_b64_tr_b16 v[114:115], v7 offset:20640
    s_waitcnt lgkmcnt(9)
    v_mfma_f32_16x16x32_bf16 v[128:131], v[116:119], v[100:103], v[128:131]
    ds_read_b128 v[100:103], v13 offset:24576
    ds_read_b64_tr_b16 v[116:117], v7 offset:21760
    ds_read_b64_tr_b16 v[118:119], v7 offset:21920
    s_waitcnt lgkmcnt(9)
    v_mfma_f32_16x16x32_bf16 v[128:131], v[120:123], v[104:107], v[128:131]
    ds_read_b128 v[104:107], v12 offset:32768
    ds_read_b64_tr_b16 v[120:121], v7 offset:23040
    ds_read_b64_tr_b16 v[122:123], v7 offset:23200
    s_waitcnt lgkmcnt(9)
    v_mfma_f32_16x16x32_bf16 v[128:131], v[124:127], v[108:111], v[128:131]
    ds_read_b128 v[108:111], v13 offset:32768
    ds_read_b64_tr_b16 v[124:125], v7 offset:24320
    ds_read_b64_tr_b16 v[126:127], v7 offset:24480
    s_waitcnt lgkmcnt(9)
    v_mfma_f32_16x16x32_bf16 v[128:131], v[112:115], v[96:99], v[128:131]
    s_waitcnt lgkmcnt(6)
    v_mfma_f32_16x16x32_bf16 v[128:131], v[116:119], v[100:103], v[128:131]
    s_waitcnt lgkmcnt(3)
    v_mfma_f32_16x16x32_bf16 v[128:131], v[120:123], v[104:107], v[128:131]
    s_waitcnt lgkmcnt(0)
    v_mfma_f32_16x16x32_bf16 v[128:131], v[124:127], v[108:111], v[128:131]
    s_lshl_b32 s56, s58, 4
    v_add_u32 v11, s56, v14
    v_mov_b32 v10, 0
    s_nop 4
    v_cvt_pk_bf16_f32 v18, v128, v129
    v_cvt_pk_bf16_f32 v19, v130, v131
    v_dot2_f32_bf16 v10, v18, v18, v10
    v_dot2_f32_bf16 v10, v19, v19, v10
    s_cmp_eq_u32 s52, 1
    s_cbranch_scc1 G_K1
    v_mov_b32 v20, v18
    v_mov_b32 v21, v19
    v_mov_b32 v8, v18
    v_mov_b32 v9, v19
    v_lshrrev_b32 v12, 1, v15
    v_lshlrev_b32 v12, 9, v12
    v_permlane16_swap_b32 v8, v20
    v_permlane16_swap_b32 v9, v21
    v_lshl_add_u32 v12, v11, 4, v12
    s_mov_b32 exec_lo, 0xffff
    s_mov_b32 exec_hi, 0xffff
    buffer_store_dwordx4 v[18:21], v12, s[32:35], s57 offen sc1
    s_mov_b64 exec, -1
    v_mov_b32 v11, v10
    s_nop 1
    v_permlane32_swap_b32 v10, v11
    s_nop 1
    v_add_f32 v10, v10, v11
    v_mov_b32 v11, v10
    s_nop 1
    v_permlane16_swap_b32 v10, v11
    s_nop 1
    v_add_f32 v10, v10, v11
    s_branch G_KN
G_K1:
    v_lshlrev_b32 v12, 3, v11
    s_mov_b64 exec, 0xffff
    buffer_store_dwordx2 v[18:19], v12, s[32:35], s57 offen offset:1024 sc1
    s_mov_b64 exec, -1
G_KN:
    s_nop 1
    v_max_f32_dpp v10, v10, v10 row_ror:8 row_mask:0xf bank_mask:0xf
    s_nop 1
    v_max_f32_dpp v10, v10, v10 row_ror:4 row_mask:0xf bank_mask:0xf
    s_nop 1
    v_max_f32_dpp v10, v10, v10 row_ror:2 row_mask:0xf bank_mask:0xf
    s_nop 1
    v_max_f32_dpp v10, v10, v10 row_ror:1 row_mask:0xf bank_mask:0xf
    s_nop 1
    s_lshl_b32 s56, s29, 2
    s_add_u32 s56, s56, s30
    s_lshl_b32 s57, s52, 7
    s_add_u32 s56, s56, s57
    s_lshl_b32 s56, s56, 2
    s_add_u32 s56, s56, 212992
    v_mov_b32 v12, s56
    s_mov_b64 exec, 1
    buffer_store_dword v10, v12, s[32:35], 0 offen sc1
    s_mov_b64 exec, -1
    s_branch G_SIG
G_JOBV:
    s_waitcnt lgkmcnt(9)
    v_mfma_f32_16x16x32_bf16 v[128:131], v[96:99], v[112:115], 0
    ds_read_b128 v[96:99], v4 offset:16384
    ds_read_b64_tr_b16 v[112:113], v7 offset:5120
    ds_read_b64_tr_b16 v[114:115], v7 offset:5280
    s_waitcnt lgkmcnt(9)
    v_mfma_f32_16x16x32_bf16 v[128:131], v[100:103], v[116:119], v[128:131]
    ds_read_b128 v[100:103], v5 offset:16384
    ds_read_b64_tr_b16 v[116:117], v7 offset:6400
    ds_read_b64_tr_b16 v[118:119], v7 offset:6560
    s_waitcnt lgkmcnt(9)
    v_mfma_f32_16x16x32_bf16 v[128:131], v[104:107], v[120:123], v[128:131]
    ds_read_b128 v[104:107], v4 offset:24576
    ds_read_b64_tr_b16 v[120:121], v7 offset:7680
    ds_read_b64_tr_b16 v[122:123], v7 offset:7840
    s_waitcnt lgkmcnt(9)
    v_mfma_f32_16x16x32_bf16 v[128:131], v[108:111], v[124:127], v[128:131]
    ds_read_b128 v[108:111], v5 offset:24576
    ds_read_b64_tr_b16 v[124:125], v7 offset:8960
    ds_read_b64_tr_b16 v[126:127], v7 offset:9120
    s_waitcnt lgkmcnt(9)
    v_mfma_f32_16x16x32_bf16 v[128:131], v[96:99], v[112:115], v[128:131]
    ds_read_b128 v[96:99], v4 offset:32768
    ds_read_b64_tr_b16 v[112:113], v7 offset:10240
    ds_read_b64_tr_b16 v[114:115], v7 offset:10400
    s_waitcnt lgkmcnt(9)
    v_mfma_f32_16x16x32_bf16 v[128:131], v[100:103], v[116:119], v[128:131]
    ds_read_b128 v[100:103], v5 offset:32768
    ds_read_b64_tr_b16 v[116:117], v7 offset:11520
    ds_read_b64_tr_b16 v[118:119], v7 offset:11680
    s_waitcnt lgkmcnt(9)
    v_mfma_f32_16x16x32_bf16 v[128:131], v[104:107], v[120:123], v[128:131]
    ds_read_b128 v[104:107], v12 offset:0
    ds_read_b64_tr_b16 v[120:121], v7 offset:12800
    ds_read_b64_tr_b16 v[122:123], v7 offset:12960
    s_waitcnt lgkmcnt(9)
    v_mfma_f32_16x16x32_bf16 v[128:131], v[108:111], v[124:127], v[128:131]
    ds_read_b128 v[108:111], v13 offset:0
    ds_read_b64_tr_b16 v[124:125], v7 offset:14080
    ds_read_b64_tr_b16 v[126:127], v7 offset:14240
    s_waitcnt lgkmcnt(9)
    v_mfma_f32_16x16x32_bf16 v[128:131], v[96:99], v[112:115], v[128:131]
    ds_read_b128 v[96:99], v12 offset:8192
    ds_read_b64_tr_b16 v[112:113], v7 offset:15360
    ds_read_b64_tr_b16 v[114:115], v7 offset:15520
    s_waitcnt lgkmcnt(9)
    v_mfma_f32_16x16x32_bf16 v[128:131], v[100:103], v[116:119], v[128:131]
    ds_read_b128 v[100:103], v13 offset:8192
    ds_read_b64_tr_b16 v[116:117], v7 offset:16640
    ds_read_b64_tr_b16 v[118:119], v7 offset:16800
    s_waitcnt lgkmcnt(9)
    v_mfma_f32_16x16x32_bf16 v[128:131], v[104:107], v[120:123], v[128:131]
    ds_read_b128 v[104:107], v12 offset:16384
    ds_read_b64_tr_b16 v[120:121], v7 offset:17920
    ds_read_b64_tr_b16 v[122:123], v7 offset:18080
    s_waitcnt lgkmcnt(9)
    v_mfma_f32_16x16x32_bf16 v[128:131], v[108:111], v[124:127], v[128:131]
    ds_read_b128 v[108:111], v13 offset:16384
    ds_read_b64_tr_b16 v[124:125], v7 offset:19200
    ds_read_b64_tr_b16 v[126:127], v7 offset:19360
    s_waitcnt lgkmcnt(9)
    v_mfma_f32_16x16x32_bf16 v[128:131], v[96:99], v[112:115], v[128:131]
    ds_read_b128 v[96:99], v12 offset:24576
    ds_read_b64_tr_b16 v[112:113], v7 offset:20480
    ds_read_b64_tr_b16 v[114:115], v7 offset:20640
    s_waitcnt lgkmcnt(9)
    v_mfma_f32_16x16x32_bf16 v[128:131], v[100:103], v[116:119], v[128:131]
    ds_read_b128 v[100:103], v13 offset:24576
    ds_read_b64_tr_b16 v[116:117], v7 offset:21760
    ds_read_b64_tr_b16 v[118:119], v7 offset:21920
    s_waitcnt lgkmcnt(9)
    v_mfma_f32_16x16x32_bf16 v[128:131], v[104:107], v[120:123], v[128:131]
    ds_read_b128 v[104:107], v12 offset:32768
    ds_read_b64_tr_b16 v[120:121], v7 offset:23040
    ds_read_b64_tr_b16 v[122:123], v7 offset:23200
    s_waitcnt lgkmcnt(9)
    v_mfma_f32_16x16x32_bf16 v[128:131], v[108:111], v[124:127], v[128:131]
    ds_read_b128 v[108:111], v13 offset:32768
    ds_read_b64_tr_b16 v[124:125], v7 offset:24320
    ds_read_b64_tr_b16 v[126:127], v7 offset:24480
    s_waitcnt lgkmcnt(9)
    v_mfma_f32_16x16x32_bf16 v[128:131], v[96:99], v[112:115], v[128:131]
    s_waitcnt lgkmcnt(6)
    v_mfma_f32_16x16x32_bf16 v[128:131], v[100:103], v[116:119], v[128:131]
    s_waitcnt lgkmcnt(3)
    v_mfma_f32_16x16x32_bf16 v[128:131], v[104:107], v[120:123], v[128:131]
    s_waitcnt lgkmcnt(0)
    v_mfma_f32_16x16x32_bf16 v[128:131], v[108:111], v[124:127], v[128:131]
    s_mul_i32 s56, s58, 704
    s_add_u32 s57, s57, s56
    s_lshl_b32 s56, s52, 8
    s_add_u32 s57, s57, s56
    v_lshrrev_b32 v10, 1, v15
    v_mul_u32_u24 v10, 22, v10
    v_add_u32 v10, v10, v14
    v_lshlrev_b32 v12, 4, v10
    s_nop 0
    v_cvt_pk_bf16_f32 v18, v128, v129
    v_cvt_pk_bf16_f32 v19, v130, v131
    s_mov_b32 s56, 0xffff
    s_cmp_eq_u32 s52, 0
    s_cbranch_scc1 G_V0
    v_cmp_eq_u32 vcc, 4, v14
    v_mov_b32 v10, 0x3f803f80
    v_cmp_gt_u32 s[64:65], 4, v14
    v_cndmask_b32 v10, 0, v10, vcc
    s_mov_b32 s56, 0x3f
    v_cndmask_b32 v18, v10, v18, s[64:65]
    v_cndmask_b32 v19, v10, v19, s[64:65]
G_V0:
    v_mov_b32 v20, v18
    v_mov_b32 v21, v19
    v_mov_b32 v8, v18
    v_mov_b32 v9, v19
    s_nop 1
    v_permlane16_swap_b32 v8, v20
    v_permlane16_swap_b32 v9, v21
    s_mov_b32 exec_lo, s56
    s_mov_b32 exec_hi, s56
    buffer_store_dwordx4 v[18:21], v12, s[32:35], s57 offen offset:1280 sc1
    s_mov_b64 exec, -1
G_SIG:
    s_cmp_eq_u32 s52, 0
    s_cbranch_scc1 G_SIG0
    s_waitcnt vmcnt(0)
    s_mov_b64 exec, 1
    ds_add_u32 v23, v24 offset:56
    s_mov_b64 exec, -1
    s_branch G_Q
G_SIG0:
    v_mov_b32 v11, 0
    s_bfe_u32 s58, s2, 0x30003
    s_lshl_b32 s58, s58, 7
    s_add_u32 s58, s58, 3866624
    v_lshlrev_b32 v13, 10, v1
    s_mov_b64 exec, 1
GP_51:
    buffer_load_dword v25, v11, s[48:51], 0 offen offset:0 sc1
    s_waitcnt vmcnt(0)
    v_cmp_gt_u32 vcc, 1, v25
    s_nop 1
    s_cmp_eq_u64 vcc, 0
    s_cbranch_scc1 GD_52
    s_sleep 4
    s_sub_u32 s71, s71, 1
    s_cbranch_scc0 GP_51
    s_mov_b32 s71, 0
GD_52:
    s_mov_b64 exec, -1
LW_53:
    ds_read_b32 v25, v23 offset:56
    s_waitcnt lgkmcnt(0)
    v_readfirstlane_b32 s70, v25
    s_cmp_ge_u32 s70, 1
    s_cbranch_scc1 LD_54
    s_sleep 1
    s_sub_u32 s71, s71, 1
    s_cbranch_scc0 LW_53
    s_mov_b32 s71, 0
LD_54:
    s_mov_b64 exec, 0xff
    buffer_atomic_add v24, v13, s[32:35], s58 offen sc1
    s_mov_b64 exec, 1
    ds_add_u32 v23, v24 offset:56
    s_mov_b64 exec, -1
G_Q:
    v_add_u32 v8, s53, v2
    v_add_u32 v9, s53, v3
    v_add_u32 v10, s54, v6
    s_add_u32 s53, s53, 8192
    s_cmp_eq_u32 s53, 81920
    s_cselect_b32 s53, 0, s53
    s_add_u32 s54, s54, 10240
    s_cmp_eq_u32 s54, 51200
    s_cselect_b32 s54, 0, s54
G_QS:
    ds_read_b32 v25, v16 offset:0
    s_waitcnt lgkmcnt(0)
    v_readfirstlane_b32 s70, v25
    s_cmp_ge_u32 s70, 7
    s_cbranch_scc1 G_QS_d
    s_sub_u32 s71, s71, 1
    s_cbranch_scc0 G_QS
    s_mov_b32 s71, 0
G_QS_d:
    ds_read_b128 v[48:51], v8
    ds_read_b64_tr_b16 v[52:53], v10 offset:0
    ds_read_b64_tr_b16 v[54:55], v10 offset:1280
    ds_read_b64_tr_b16 v[56:57], v10 offset:8
    ds_read_b64_tr_b16 v[58:59], v10 offset:1288
    ds_read_b64_tr_b16 v[60:61], v10 offset:16
    ds_read_b64_tr_b16 v[62:63], v10 offset:1296
    ds_read_b64_tr_b16 v[64:65], v10 offset:24
    ds_read_b64_tr_b16 v[66:67], v10 offset:1304
    ds_read_b64_tr_b16 v[68:69], v10 offset:32
    ds_read_b64_tr_b16 v[70:71], v10 offset:1312
    ds_read_b128 v[72:75], v9
    ds_read_b64_tr_b16 v[76:77], v10 offset:5120
    ds_read_b64_tr_b16 v[78:79], v10 offset:6400
    ds_read_b64_tr_b16 v[80:81], v10 offset:5128
    ds_read_b64_tr_b16 v[82:83], v10 offset:6408
    ds_read_b64_tr_b16 v[84:85], v10 offset:5136
    ds_read_b64_tr_b16 v[86:87], v10 offset:6416
    ds_read_b64_tr_b16 v[88:89], v10 offset:5144
    ds_read_b64_tr_b16 v[90:91], v10 offset:6424
    ds_read_b64_tr_b16 v[92:93], v10 offset:5152
    ds_read_b64_tr_b16 v[94:95], v10 offset:6432
    ds_read_b32 v25, v16 offset:4
G_QT0:
    v_add_u32 v8, s53, v2
    v_add_u32 v9, s53, v3
    v_add_u32 v10, s54, v6
    s_add_u32 s53, s53, 8192
    s_cmp_eq_u32 s53, 81920
    s_cselect_b32 s53, 0, s53
    s_add_u32 s54, s54, 10240
    s_cmp_eq_u32 s54, 51200
    s_cselect_b32 s54, 0, s54
    s_add_u32 s55, s55, 1
    s_waitcnt lgkmcnt(0)
    v_readfirstlane_b32 s70, v25
    s_mov_b64 exec, 1
    ds_add_u32 v16, v24 offset:128
    s_mov_b64 exec, -1
    v_add_u32 v16, 4, v16
    s_cmp_ge_u32 s70, 7
    s_cbranch_scc0 G_QSLOW0
    ds_read_b128 v[96:99], v8
    ds_read_b64_tr_b16 v[100:101], v10 offset:0
    ds_read_b64_tr_b16 v[102:103], v10 offset:1280
    v_mfma_f32_16x16x32_bf16 v[26:29], v[52:55], v[48:51], v[26:29]
    ds_read_b64_tr_b16 v[104:105], v10 offset:8
    ds_read_b64_tr_b16 v[106:107], v10 offset:1288
    ds_read_b64_tr_b16 v[108:109], v10 offset:16
    v_mfma_f32_16x16x32_bf16 v[30:33], v[56:59], v[48:51], v[30:33]
    ds_read_b64_tr_b16 v[110:111], v10 offset:1296
    ds_read_b64_tr_b16 v[112:113], v10 offset:24
    ds_read_b64_tr_b16 v[114:115], v10 offset:1304
    v_mfma_f32_16x16x32_bf16 v[34:37], v[60:63], v[48:51], v[34:37]
    ds_read_b64_tr_b16 v[116:117], v10 offset:32
    ds_read_b64_tr_b16 v[118:119], v10 offset:1312
    v_mfma_f32_16x16x32_bf16 v[38:41], v[64:67], v[48:51], v[38:41]
    ds_read_b128 v[120:123], v9
    ds_read_b64_tr_b16 v[124:125], v10 offset:5120
    v_mfma_f32_16x16x32_bf16 v[42:45], v[68:71], v[48:51], v[42:45]
    ds_read_b64_tr_b16 v[126:127], v10 offset:6400
    ds_read_b64_tr_b16 v[128:129], v10 offset:5128
    v_mfma_f32_16x16x32_bf16 v[26:29], v[76:79], v[72:75], v[26:29]
    ds_read_b64_tr_b16 v[130:131], v10 offset:6408
    ds_read_b64_tr_b16 v[132:133], v10 offset:5136
    v_mfma_f32_16x16x32_bf16 v[30:33], v[80:83], v[72:75], v[30:33]
    ds_read_b64_tr_b16 v[134:135], v10 offset:6416
    ds_read_b64_tr_b16 v[136:137], v10 offset:5144
    v_mfma_f32_16x16x32_bf16 v[34:37], v[84:87], v[72:75], v[34:37]
    ds_read_b64_tr_b16 v[138:139], v10 offset:6424
    ds_read_b64_tr_b16 v[140:141], v10 offset:5152
    v_mfma_f32_16x16x32_bf16 v[38:41], v[88:91], v[72:75], v[38:41]
    ds_read_b64_tr_b16 v[142:143], v10 offset:6432
    ds_read_b32 v25, v16 offset:4
    v_mfma_f32_16x16x32_bf16 v[42:45], v[92:95], v[72:75], v[42:45]
G_QT1:
    v_add_u32 v8, s53, v2
    v_add_u32 v9, s53, v3
    v_add_u32 v10, s54, v6
    s_add_u32 s53, s53, 8192
    s_cmp_eq_u32 s53, 81920
    s_cselect_b32 s53, 0, s53
    s_add_u32 s54, s54, 10240
    s_cmp_eq_u32 s54, 51200
    s_cselect_b32 s54, 0, s54
    s_add_u32 s55, s55, 1
    s_waitcnt lgkmcnt(0)
    v_readfirstlane_b32 s70, v25
    s_mov_b64 exec, 1
    ds_add_u32 v16, v24 offset:128
    s_mov_b64 exec, -1
    v_add_u32 v16, 4, v16
    s_cmp_eq_u32 s55, 10
    s_cbranch_scc1 G_QFIN
    s_cmp_ge_u32 s70, 7
    s_cbranch_scc0 G_QSLOW1
    ds_read_b128 v[48:51], v8
    ds_read_b64_tr_b16 v[52:53], v10 offset:0
    ds_read_b64_tr_b16 v[54:55], v10 offset:1280
    v_mfma_f32_16x16x32_bf16 v[26:29], v[100:103], v[96:99], v[26:29]
    ds_read_b64_tr_b16 v[56:57], v10 offset:8
    ds_read_b64_tr_b16 v[58:59], v10 offset:1288
    ds_read_b64_tr_b16 v[60:61], v10 offset:16
    v_mfma_f32_16x16x32_bf16 v[30:33], v[104:107], v[96:99], v[30:33]
    ds_read_b64_tr_b16 v[62:63], v10 offset:1296
    ds_read_b64_tr_b16 v[64:65], v10 offset:24
    ds_read_b64_tr_b16 v[66:67], v10 offset:1304
    v_mfma_f32_16x16x32_bf16 v[34:37], v[108:111], v[96:99], v[34:37]
    ds_read_b64_tr_b16 v[68:69], v10 offset:32
    ds_read_b64_tr_b16 v[70:71], v10 offset:1312
    v_mfma_f32_16x16x32_bf16 v[38:41], v[112:115], v[96:99], v[38:41]
    ds_read_b128 v[72:75], v9
    ds_read_b64_tr_b16 v[76:77], v10 offset:5120
    v_mfma_f32_16x16x32_bf16 v[42:45], v[116:119], v[96:99], v[42:45]
    ds_read_b64_tr_b16 v[78:79], v10 offset:6400
    ds_read_b64_tr_b16 v[80:81], v10 offset:5128
    v_mfma_f32_16x16x32_bf16 v[26:29], v[124:127], v[120:123], v[26:29]
    ds_read_b64_tr_b16 v[82:83], v10 offset:6408
    ds_read_b64_tr_b16 v[84:85], v10 offset:5136
    v_mfma_f32_16x16x32_bf16 v[30:33], v[128:131], v[120:123], v[30:33]
    ds_read_b64_tr_b16 v[86:87], v10 offset:6416
    ds_read_b64_tr_b16 v[88:89], v10 offset:5144
    v_mfma_f32_16x16x32_bf16 v[34:37], v[132:135], v[120:123], v[34:37]
    ds_read_b64_tr_b16 v[90:91], v10 offset:6424
    ds_read_b64_tr_b16 v[92:93], v10 offset:5152
    v_mfma_f32_16x16x32_bf16 v[38:41], v[136:139], v[120:123], v[38:41]
    ds_read_b64_tr_b16 v[94:95], v10 offset:6432
    ds_read_b32 v25, v16 offset:4
    v_mfma_f32_16x16x32_bf16 v[42:45], v[140:143], v[120:123], v[42:45]
    s_branch G_QT0
G_QSLOW0:
    v_mfma_f32_16x16x32_bf16 v[26:29], v[52:55], v[48:51], v[26:29]
    v_mfma_f32_16x16x32_bf16 v[30:33], v[56:59], v[48:51], v[30:33]
    v_mfma_f32_16x16x32_bf16 v[34:37], v[60:63], v[48:51], v[34:37]
    v_mfma_f32_16x16x32_bf16 v[38:41], v[64:67], v[48:51], v[38:41]
    v_mfma_f32_16x16x32_bf16 v[42:45], v[68:71], v[48:51], v[42:45]
    v_mfma_f32_16x16x32_bf16 v[26:29], v[76:79], v[72:75], v[26:29]
    v_mfma_f32_16x16x32_bf16 v[30:33], v[80:83], v[72:75], v[30:33]
    v_mfma_f32_16x16x32_bf16 v[34:37], v[84:87], v[72:75], v[34:37]
    v_mfma_f32_16x16x32_bf16 v[38:41], v[88:91], v[72:75], v[38:41]
    v_mfma_f32_16x16x32_bf16 v[42:45], v[92:95], v[72:75], v[42:45]
G_QW0:
    ds_read_b32 v25, v16 offset:0
    s_waitcnt lgkmcnt(0)
    v_readfirstlane_b32 s70, v25
    s_cmp_ge_u32 s70, 7
    s_cbranch_scc1 G_QW0_d
    s_sub_u32 s71, s71, 1
    s_cbranch_scc0 G_QW0
    s_mov_b32 s71, 0
G_QW0_d:
    ds_read_b128 v[96:99], v8
    ds_read_b64_tr_b16 v[100:101], v10 offset:0
    ds_read_b64_tr_b16 v[102:103], v10 offset:1280
    ds_read_b64_tr_b16 v[104:105], v10 offset:8
    ds_read_b64_tr_b16 v[106:107], v10 offset:1288
    ds_read_b64_tr_b16 v[108:109], v10 offset:16
    ds_read_b64_tr_b16 v[110:111], v10 offset:1296
    ds_read_b64_tr_b16 v[112:113], v10 offset:24
    ds_read_b64_tr_b16 v[114:115], v10 offset:1304
    ds_read_b64_tr_b16 v[116:117], v10 offset:32
    ds_read_b64_tr_b16 v[118:119], v10 offset:1312
    ds_read_b128 v[120:123], v9
    ds_read_b64_tr_b16 v[124:125], v10 offset:5120
    ds_read_b64_tr_b16 v[126:127], v10 offset:6400
    ds_read_b64_tr_b16 v[128:129], v10 offset:5128
    ds_read_b64_tr_b16 v[130:131], v10 offset:6408
    ds_read_b64_tr_b16 v[132:133], v10 offset:5136
    ds_read_b64_tr_b16 v[134:135], v10 offset:6416
    ds_read_b64_tr_b16 v[136:137], v10 offset:5144
    ds_read_b64_tr_b16 v[138:139], v10 offset:6424
    ds_read_b64_tr_b16 v[140:141], v10 offset:5152
    ds_read_b64_tr_b16 v[142:143], v10 offset:6432
    ds_read_b32 v25, v16 offset:4
    s_branch G_QT1
G_QSLOW1:
    v_mfma_f32_16x16x32_bf16 v[26:29], v[100:103], v[96:99], v[26:29]
    v_mfma_f32_16x16x32_bf16 v[30:33], v[104:107], v[96:99], v[30:33]
    v_mfma_f32_16x16x32_bf16 v[34:37], v[108:111], v[96:99], v[34:37]
    v_mfma_f32_16x16x32_bf16 v[38:41], v[112:115], v[96:99], v[38:41]
    v_mfma_f32_16x16x32_bf16 v[42:45], v[116:119], v[96:99], v[42:45]
    v_mfma_f32_16x16x32_bf16 v[26:29], v[124:127], v[120:123], v[26:29]
    v_mfma_f32_16x16x32_bf16 v[30:33], v[128:131], v[120:123], v[30:33]
    v_mfma_f32_16x16x32_bf16 v[34:37], v[132:135], v[120:123], v[34:37]
    v_mfma_f32_16x16x32_bf16 v[38:41], v[136:139], v[120:123], v[38:41]
    v_mfma_f32_16x16x32_bf16 v[42:45], v[140:143], v[120:123], v[42:45]
G_QW1:
    ds_read_b32 v25, v16 offset:0
    s_waitcnt lgkmcnt(0)
    v_readfirstlane_b32 s70, v25
    s_cmp_ge_u32 s70, 7
    s_cbranch_scc1 G_QW1_d
    s_sub_u32 s71, s71, 1
    s_cbranch_scc0 G_QW1
    s_mov_b32 s71, 0
G_QW1_d:
    ds_read_b128 v[48:51], v8
    ds_read_b64_tr_b16 v[52:53], v10 offset:0
    ds_read_b64_tr_b16 v[54:55], v10 offset:1280
    ds_read_b64_tr_b16 v[56:57], v10 offset:8
    ds_read_b64_tr_b16 v[58:59], v10 offset:1288
    ds_read_b64_tr_b16 v[60:61], v10 offset:16
    ds_read_b64_tr_b16 v[62:63], v10 offset:1296
    ds_read_b64_tr_b16 v[64:65], v10 offset:24
    ds_read_b64_tr_b16 v[66:67], v10 offset:1304
    ds_read_b64_tr_b16 v[68:69], v10 offset:32
    ds_read_b64_tr_b16 v[70:71], v10 offset:1312
    ds_read_b128 v[72:75], v9
    ds_read_b64_tr_b16 v[76:77], v10 offset:5120
    ds_read_b64_tr_b16 v[78:79], v10 offset:6400
    ds_read_b64_tr_b16 v[80:81], v10 offset:5128
    ds_read_b64_tr_b16 v[82:83], v10 offset:6408
    ds_read_b64_tr_b16 v[84:85], v10 offset:5136
    ds_read_b64_tr_b16 v[86:87], v10 offset:6416
    ds_read_b64_tr_b16 v[88:89], v10 offset:5144
    ds_read_b64_tr_b16 v[90:91], v10 offset:6424
    ds_read_b64_tr_b16 v[92:93], v10 offset:5152
    ds_read_b64_tr_b16 v[94:95], v10 offset:6432
    ds_read_b32 v25, v16 offset:4
    s_branch G_QT0
G_QFIN:
    v_mfma_f32_16x16x32_bf16 v[26:29], v[100:103], v[96:99], v[26:29]
    v_mfma_f32_16x16x32_bf16 v[30:33], v[104:107], v[96:99], v[30:33]
    v_mfma_f32_16x16x32_bf16 v[34:37], v[108:111], v[96:99], v[34:37]
    v_mfma_f32_16x16x32_bf16 v[38:41], v[112:115], v[96:99], v[38:41]
    v_mfma_f32_16x16x32_bf16 v[42:45], v[116:119], v[96:99], v[42:45]
    v_mfma_f32_16x16x32_bf16 v[26:29], v[124:127], v[120:123], v[26:29]
    v_mfma_f32_16x16x32_bf16 v[30:33], v[128:131], v[120:123], v[30:33]
    v_mfma_f32_16x16x32_bf16 v[34:37], v[132:135], v[120:123], v[34:37]
    v_mfma_f32_16x16x32_bf16 v[38:41], v[136:139], v[120:123], v[38:41]
    v_mfma_f32_16x16x32_bf16 v[42:45], v[140:143], v[120:123], v[42:45]
    s_lshl_b32 s56, s52, 4
    v_add_u32 v8, s56, v14
    v_mul_u32_u24 v8, 48, v8
    v_mul_u32_u24 v9, 3072, v15
    v_add_u32 v8, v8, v9
    v_add_u32 v8, 81920, v8
LW_55:
    ds_read_b32 v25, v23 offset:152
    s_waitcnt lgkmcnt(0)
    v_readfirstlane_b32 s70, v25
    s_cmp_ge_u32 s70, 4
    s_cbranch_scc1 LD_56
    s_sleep 1
    s_sub_u32 s71, s71, 1
    s_cbranch_scc0 LW_55
    s_mov_b32 s71, 0
LD_56:
    v_pk_mul_f32 v[26:27], v[26:27], s[62:63]
    v_pk_mul_f32 v[28:29], v[28:29], s[62:63]
    v_pk_mul_f32 v[30:31], v[30:31], s[62:63]
    v_pk_mul_f32 v[32:33], v[32:33], s[62:63]
    v_pk_mul_f32 v[34:35], v[34:35], s[62:63]
    v_pk_mul_f32 v[36:37], v[36:37], s[62:63]
    v_pk_mul_f32 v[38:39], v[38:39], s[62:63]
    v_pk_mul_f32 v[40:41], v[40:41], s[62:63]
    v_pk_mul_f32 v[42:43], v[42:43], s[62:63]
    v_pk_mul_f32 v[44:45], v[44:45], s[62:63]
    v_cvt_pk_bf16_f32 v144, v26, v27
    v_cvt_pk_bf16_f32 v145, v28, v29
    v_cvt_pk_bf16_f32 v146, v30, v31
    v_cvt_pk_bf16_f32 v147, v32, v33
    v_cvt_pk_bf16_f32 v148, v34, v35
    v_cvt_pk_bf16_f32 v149, v36, v37
    v_cvt_pk_bf16_f32 v150, v38, v39
    v_cvt_pk_bf16_f32 v151, v40, v41
    v_cvt_pk_bf16_f32 v152, v42, v43
    v_cvt_pk_bf16_f32 v153, v44, v45
    ds_write_b128 v8, v[144:147]
    ds_write_b128 v8, v[148:151] offset:16
    ds_write_b64 v8, v[152:153] offset:32
    s_waitcnt lgkmcnt(0)
    s_mov_b64 exec, 1
    ds_add_u32 v23, v24 offset:44
    s_mov_b64 exec, -1
    s_setprio 2
    v_and_b32 v14, 31, v1
    v_lshrrev_b32 v15, 5, v1
    v_bfe_u32 v2, v14, 1, 3
    v_xor_b32 v2, v2, v15
    v_lshlrev_b32 v2, 4, v2
    v_lshl_add_u32 v2, v14, 7, v2
    v_xor_b32 v3, 32, v2
    v_xor_b32 v4, 64, v2
    v_xor_b32 v5, 96, v2
    v_lshrrev_b32 v8, 3, v14
    v_and_b32 v9, 3, v14
    v_lshl_add_u32 v8, v8, 2, v9
    v_bfe_u32 v9, v14, 2, 1
    v_mul_u32_u24 v10, 640, v9
    v_lshl_add_u32 v10, v15, 4, v10
    v_lshl_add_u32 v6, v8, 5, v10
    v_lshl_add_u32 v11, v9, 3, v8
    v_lshlrev_b32 v12, 2, v9
    v_sub_u32 v12, 8, v12
    v_cmp_le_u32 vcc, 12, v8
    v_add_u32 v7, 512, v6
    v_lshlrev_b32 v13, 4, v15
    v_cndmask_b32 v12, 0, v12, vcc
    v_add_u32 v11, v11, v12
    v_lshl_add_u32 v11, v11, 5, v13
    v_cmp_gt_u32 vcc, 4, v8
    v_add_u32 v11, 1152, v11
    s_nop 0
    v_cndmask_b32 v7, v11, v7, vcc
    v_mov_b32 v16, v14
    v_mov_b32 v17, v15
    s_mul_i32 s64, s66, 81920
    s_add_u32 s64, s64, 4194304
    s_add_u32 s65, s64, 81920
    s_and_b32 s54, s29, 0
    s_lshl_b32 s56, s54, 14
    s_add_u32 s53, s64, s56
    v_add_u32 v2, s56, v2
    v_add_u32 v3, s56, v3
    v_add_u32 v4, s56, v4
    v_add_u32 v5, s56, v5
    v_mov_b32 v40, 0
    v_mov_b32 v41, 0
    v_mov_b32 v42, 0
    v_mov_b32 v43, 0
    v_mov_b32 v44, 0
    v_mov_b32 v45, 0
    v_mov_b32 v46, 0
    v_mov_b32 v47, 0
    v_mov_b32 v48, 0
    v_mov_b32 v49, 0
    v_mov_b32 v50, 0
    v_mov_b32 v51, 0
    v_mov_b32 v52, 0
    v_mov_b32 v53, 0
    v_mov_b32 v54, 0
    v_mov_b32 v55, 0
    v_mov_b32 v56, 0
    v_mov_b32 v57, 0
    v_mov_b32 v58, 0
    v_mov_b32 v59, 0
    v_mov_b32 v60, 0
    v_mov_b32 v61, 0
    v_mov_b32 v62, 0
    v_mov_b32 v63, 0
    v_mov_b32 v64, 0
    v_mov_b32 v65, 0
    v_mov_b32 v66, 0
    v_mov_b32 v67, 0
    v_mov_b32 v68, 0
    v_mov_b32 v69, 0
    v_mov_b32 v70, 0
    v_mov_b32 v71, 0
    v_mov_b32 v72, 0
    v_mov_b32 v73, 0
    v_mov_b32 v74, 0
    v_mov_b32 v75, 0
    v_mov_b32 v76, 0
    v_mov_b32 v77, 0
    v_mov_b32 v78, 0
    v_mov_b32 v79, 0
    v_mov_b32 v80, 0
    v_mov_b32 v81, 0
    v_mov_b32 v82, 0
    v_mov_b32 v83, 0
    v_mov_b32 v84, 0
    v_mov_b32 v85, 0
    v_mov_b32 v86, 0
    v_mov_b32 v87, 0
    v_mov_b32 v88, 0
    v_mov_b32 v89, 0
    v_mov_b32 v90, 0
    v_mov_b32 v91, 0
    v_mov_b32 v92, 0
    v_mov_b32 v93, 0
    v_mov_b32 v94, 0
    v_mov_b32 v95, 0
    v_mov_b32 v96, 0
    v_mov_b32 v97, 0
    v_mov_b32 v98, 0
    v_mov_b32 v99, 0
    v_mov_b32 v100, 0
    v_mov_b32 v101, 0
    v_mov_b32 v102, 0
    v_mov_b32 v103, 0
    s_cmp_lg_u32 s52, 0
    s_cbranch_scc1 G_GOW
    s_and_b32 s58, s2, 7
    s_lshl_b32 s58, s58, 10
    s_add_u32 s58, s58, 3874816
    v_lshlrev_b32 v13, 7, v1
    v_add_u32 v13, s58, v13
    s_mov_b64 exec, 0xff
GP_57:
    buffer_load_dword v25, v13, s[32:35], 0 offen offset:0 sc1
    s_waitcnt vmcnt(0)
    v_cmp_gt_u32 vcc, 32, v25
    s_nop 1
    s_cmp_eq_u64 vcc, 0
    s_cbranch_scc1 GD_58
    s_sleep 12
    s_sub_u32 s71, s71, 1
    s_cbranch_scc0 GP_57
    s_mov_b32 s71, 0
GD_58:
    s_mov_b64 exec, -1
    s_mov_b64 exec, 1
    ds_add_u32 v23, v24 offset:168
    s_mov_b64 exec, -1
G_GOW:
LW_59:
    ds_read_b32 v25, v23 offset:168
    s_waitcnt lgkmcnt(0)
    v_readfirstlane_b32 s70, v25
    s_cmp_ge_u32 s70, 1
    s_cbranch_scc1 LD_60
    s_sleep 2
    s_sub_u32 s71, s71, 1
    s_cbranch_scc0 LW_59
    s_mov_b32 s71, 0
LD_60:
    buffer_load_dwordx4 v[104:107], v6, s[32:35], s53 offen offset:0 sc1
    buffer_load_dwordx4 v[108:111], v7, s[32:35], s53 offen offset:0 sc1
    buffer_load_dwordx4 v[112:115], v6, s[32:35], s53 offen offset:2048 sc1
    buffer_load_dwordx4 v[116:119], v7, s[32:35], s53 offen offset:2048 sc1
    s_add_u32 s53, s53, 4096
    buffer_load_dwordx4 v[120:123], v6, s[32:35], s53 offen offset:0 sc1
    buffer_load_dwordx4 v[124:127], v7, s[32:35], s53 offen offset:0 sc1
    buffer_load_dwordx4 v[128:131], v6, s[32:35], s53 offen offset:2048 sc1
    buffer_load_dwordx4 v[132:135], v7, s[32:35], s53 offen offset:2048 sc1
    s_add_u32 s53, s53, 4096
    buffer_load_dwordx4 v[136:139], v6, s[32:35], s53 offen offset:0 sc1
    buffer_load_dwordx4 v[140:143], v7, s[32:35], s53 offen offset:0 sc1
    buffer_load_dwordx4 v[144:147], v6, s[32:35], s53 offen offset:2048 sc1
    buffer_load_dwordx4 v[148:151], v7, s[32:35], s53 offen offset:2048 sc1
    s_add_u32 s53, s53, 4096
    buffer_load_dwordx4 v[152:155], v6, s[32:35], s53 offen offset:0 sc1
    buffer_load_dwordx4 v[156:159], v7, s[32:35], s53 offen offset:0 sc1
    buffer_load_dwordx4 v[160:163], v6, s[32:35], s53 offen offset:2048 sc1
    buffer_load_dwordx4 v[164:167], v7, s[32:35], s53 offen offset:2048 sc1
    s_add_u32 s53, s53, 4096
    s_cmp_eq_u32 s53, s65
    s_cselect_b32 s53, s64, s53
    ds_read_b128 v[8:11], v2 offset:0
    ds_read_b128 v[12:15], v2 offset:4096
    s_mov_b32 s55, 0
    s_setprio 0
G_A1:
    s_setprio 2
    ds_read_b128 v[26:29], v3 offset:0
    ds_read_b128 v[30:33], v3 offset:4096
    s_waitcnt vmcnt(14) lgkmcnt(2)
    v_mfma_f32_32x32x16_bf16 v[40:55], v[104:107], v[8:11], v[40:55]
    v_mfma_f32_32x32x16_bf16 v[72:87], v[104:107], v[12:15], v[72:87]
    v_mfma_f32_32x32x16_bf16 v[56:71], v[108:111], v[8:11], v[56:71]
    v_mfma_f32_32x32x16_bf16 v[88:103], v[108:111], v[12:15], v[88:103]
    buffer_load_dwordx4 v[104:107], v6, s[32:35], s53 offen offset:0 sc1
    buffer_load_dwordx4 v[108:111], v7, s[32:35], s53 offen offset:0 sc1
    ds_read_b128 v[8:11], v4 offset:0
    ds_read_b128 v[12:15], v4 offset:4096
    s_waitcnt vmcnt(14) lgkmcnt(2)
    v_mfma_f32_32x32x16_bf16 v[40:55], v[112:115], v[26:29], v[40:55]
    v_mfma_f32_32x32x16_bf16 v[72:87], v[112:115], v[30:33], v[72:87]
    v_mfma_f32_32x32x16_bf16 v[56:71], v[116:119], v[26:29], v[56:71]
    v_mfma_f32_32x32x16_bf16 v[88:103], v[116:119], v[30:33], v[88:103]
    buffer_load_dwordx4 v[112:115], v6, s[32:35], s53 offen offset:2048 sc1
    buffer_load_dwordx4 v[116:119], v7, s[32:35], s53 offen offset:2048 sc1
    s_add_u32 s53, s53, 4096
    s_setprio 0
    ds_read_b128 v[26:29], v5 offset:0
    ds_read_b128 v[30:33], v5 offset:4096
    s_waitcnt vmcnt(14) lgkmcnt(2)
    v_mfma_f32_32x32x16_bf16 v[40:55], v[120:123], v[8:11], v[40:55]
    v_mfma_f32_32x32x16_bf16 v[72:87], v[120:123], v[12:15], v[72:87]
    v_mfma_f32_32x32x16_bf16 v[56:71], v[124:127], v[8:11], v[56:71]
    v_mfma_f32_32x32x16_bf16 v[88:103], v[124:127], v[12:15], v[88:103]
    buffer_load_dwordx4 v[120:123], v6, s[32:35], s53 offen offset:0 sc1
    buffer_load_dwordx4 v[124:127], v7, s[32:35], s53 offen offset:0 sc1
    ds_read_b128 v[8:11], v2 offset:8192
    ds_read_b128 v[12:15], v2 offset:12288
    s_waitcnt vmcnt(14) lgkmcnt(2)
    v_mfma_f32_32x32x16_bf16 v[40:55], v[128:131], v[26:29], v[40:55]
    v_mfma_f32_32x32x16_bf16 v[72:87], v[128:131], v[30:33], v[72:87]
    v_mfma_f32_32x32x16_bf16 v[56:71], v[132:135], v[26:29], v[56:71]
    v_mfma_f32_32x32x16_bf16 v[88:103], v[132:135], v[30:33], v[88:103]
    buffer_load_dwordx4 v[128:131], v6, s[32:35], s53 offen offset:2048 sc1
    buffer_load_dwordx4 v[132:135], v7, s[32:35], s53 offen offset:2048 sc1
    s_add_u32 s53, s53, 4096
    s_setprio 2
    ds_read_b128 v[26:29], v3 offset:8192
    ds_read_b128 v[30:33], v3 offset:12288
    s_waitcnt vmcnt(14) lgkmcnt(2)
    v_mfma_f32_32x32x16_bf16 v[40:55], v[136:139], v[8:11], v[40:55]
    v_mfma_f32_32x32x16_bf16 v[72:87], v[136:139], v[12:15], v[72:87]
    v_mfma_f32_32x32x16_bf16 v[56:71], v[140:143], v[8:11], v[56:71]
    v_mfma_f32_32x32x16_bf16 v[88:103], v[140:143], v[12:15], v[88:103]
    buffer_load_dwordx4 v[136:139], v6, s[32:35], s53 offen offset:0 sc1
    buffer_load_dwordx4 v[140:143], v7, s[32:35], s53 offen offset:0 sc1
    ds_read_b128 v[8:11], v4 offset:8192
    ds_read_b128 v[12:15], v4 offset:12288
    s_waitcnt vmcnt(14) lgkmcnt(2)
    v_mfma_f32_32x32x16_bf16 v[40:55], v[144:147], v[26:29], v[40:55]
    v_mfma_f32_32x32x16_bf16 v[72:87], v[144:147], v[30:33], v[72:87]
    v_mfma_f32_32x32x16_bf16 v[56:71], v[148:151], v[26:29], v[56:71]
    v_mfma_f32_32x32x16_bf16 v[88:103], v[148:151], v[30:33], v[88:103]
    buffer_load_dwordx4 v[144:147], v6, s[32:35], s53 offen offset:2048 sc1
    buffer_load_dwordx4 v[148:151], v7, s[32:35], s53 offen offset:2048 sc1
    s_add_u32 s53, s53, 4096
    s_setprio 0
    ds_read_b128 v[26:29], v5 offset:8192
    ds_read_b128 v[30:33], v5 offset:12288
    s_waitcnt vmcnt(14) lgkmcnt(2)
    v_mfma_f32_32x32x16_bf16 v[40:55], v[152:155], v[8:11], v[40:55]
    v_mfma_f32_32x32x16_bf16 v[72:87], v[152:155], v[12:15], v[72:87]
    v_mfma_f32_32x32x16_bf16 v[56:71], v[156:159], v[8:11], v[56:71]
    v_mfma_f32_32x32x16_bf16 v[88:103], v[156:159], v[12:15], v[88:103]
    buffer_load_dwordx4 v[152:155], v6, s[32:35], s53 offen offset:0 sc1
    buffer_load_dwordx4 v[156:159], v7, s[32:35], s53 offen offset:0 sc1
    s_add_u32 s54, s54, 1
    s_cmp_eq_u32 s54, 5
    s_movk_i32 s56, 0x4000
    s_cselect_b32 s56, 0xffff0000, s56
    v_add_u32 v2, s56, v2
    v_add_u32 v3, s56, v3
    v_add_u32 v4, s56, v4
    v_add_u32 v5, s56, v5
    ds_read_b128 v[8:11], v2 offset:0
    ds_read_b128 v[12:15], v2 offset:4096
    s_waitcnt vmcnt(14) lgkmcnt(2)
    v_mfma_f32_32x32x16_bf16 v[40:55], v[160:163], v[26:29], v[40:55]
    v_mfma_f32_32x32x16_bf16 v[72:87], v[160:163], v[30:33], v[72:87]
    v_mfma_f32_32x32x16_bf16 v[56:71], v[164:167], v[26:29], v[56:71]
    v_mfma_f32_32x32x16_bf16 v[88:103], v[164:167], v[30:33], v[88:103]
    buffer_load_dwordx4 v[160:163], v6, s[32:35], s53 offen offset:2048 sc1
    buffer_load_dwordx4 v[164:167], v7, s[32:35], s53 offen offset:2048 sc1
    s_add_u32 s53, s53, 4096
    s_cmp_eq_u32 s53, s65
    s_cselect_b32 s53, s64, s53
    s_add_u32 s55, s55, 1
    s_cmp_lt_u32 s55, 4
    s_cbranch_scc1 G_A1
    s_setprio 2
    ds_read_b128 v[26:29], v3 offset:0
    ds_read_b128 v[30:33], v3 offset:4096
    s_waitcnt vmcnt(14) lgkmcnt(2)
    v_mfma_f32_32x32x16_bf16 v[40:55], v[104:107], v[8:11], v[40:55]
    v_mfma_f32_32x32x16_bf16 v[72:87], v[104:107], v[12:15], v[72:87]
    v_mfma_f32_32x32x16_bf16 v[56:71], v[108:111], v[8:11], v[56:71]
    v_mfma_f32_32x32x16_bf16 v[88:103], v[108:111], v[12:15], v[88:103]
    ds_read_b128 v[8:11], v4 offset:0
    ds_read_b128 v[12:15], v4 offset:4096
    s_waitcnt vmcnt(12) lgkmcnt(2)
    v_mfma_f32_32x32x16_bf16 v[40:55], v[112:115], v[26:29], v[40:55]
    v_mfma_f32_32x32x16_bf16 v[72:87], v[112:115], v[30:33], v[72:87]
    v_mfma_f32_32x32x16_bf16 v[56:71], v[116:119], v[26:29], v[56:71]
    v_mfma_f32_32x32x16_bf16 v[88:103], v[116:119], v[30:33], v[88:103]
    s_setprio 0
    ds_read_b128 v[26:29], v5 offset:0
    ds_read_b128 v[30:33], v5 offset:4096
    s_waitcnt vmcnt(10) lgkmcnt(2)
    v_mfma_f32_32x32x16_bf16 v[40:55], v[120:123], v[8:11], v[40:55]
    v_mfma_f32_32x32x16_bf16 v[72:87], v[120:123], v[12:15], v[72:87]
    v_mfma_f32_32x32x16_bf16 v[56:71], v[124:127], v[8:11], v[56:71]
    v_mfma_f32_32x32x16_bf16 v[88:103], v[124:127], v[12:15], v[88:103]
    ds_read_b128 v[8:11], v2 offset:8192
    ds_read_b128 v[12:15], v2 offset:12288
    s_waitcnt vmcnt(8) lgkmcnt(2)
    v_mfma_f32_32x32x16_bf16 v[40:55], v[128:131], v[26:29], v[40:55]
    v_mfma_f32_32x32x16_bf16 v[72:87], v[128:131], v[30:33], v[72:87]
    v_mfma_f32_32x32x16_bf16 v[56:71], v[132:135], v[26:29], v[56:71]
    v_mfma_f32_32x32x16_bf16 v[88:103], v[132:135], v[30:33], v[88:103]
    s_setprio 2
    ds_read_b128 v[26:29], v3 offset:8192
    ds_read_b128 v[30:33], v3 offset:12288
    s_waitcnt vmcnt(6) lgkmcnt(2)
    v_mfma_f32_32x32x16_bf16 v[40:55], v[136:139], v[8:11], v[40:55]
    v_mfma_f32_32x32x16_bf16 v[72:87], v[136:139], v[12:15], v[72:87]
    v_mfma_f32_32x32x16_bf16 v[56:71], v[140:143], v[8:11], v[56:71]
    v_mfma_f32_32x32x16_bf16 v[88:103], v[140:143], v[12:15], v[88:103]
    ds_read_b128 v[8:11], v4 offset:8192
    ds_read_b128 v[12:15], v4 offset:12288
    s_waitcnt vmcnt(4) lgkmcnt(2)
    v_mfma_f32_32x32x16_bf16 v[40:55], v[144:147], v[26:29], v[40:55]
    v_mfma_f32_32x32x16_bf16 v[72:87], v[144:147], v[30:33], v[72:87]
    v_mfma_f32_32x32x16_bf16 v[56:71], v[148:151], v[26:29], v[56:71]
    v_mfma_f32_32x32x16_bf16 v[88:103], v[148:151], v[30:33], v[88:103]
    s_setprio 0
    ds_read_b128 v[26:29], v5 offset:8192
    ds_read_b128 v[30:33], v5 offset:12288
    s_waitcnt vmcnt(2) lgkmcnt(2)
    v_mfma_f32_32x32x16_bf16 v[40:55], v[152:155], v[8:11], v[40:55]
    v_mfma_f32_32x32x16_bf16 v[72:87], v[152:155], v[12:15], v[72:87]
    v_mfma_f32_32x32x16_bf16 v[56:71], v[156:159], v[8:11], v[56:71]
    v_mfma_f32_32x32x16_bf16 v[88:103], v[156:159], v[12:15], v[88:103]
    s_waitcnt vmcnt(0) lgkmcnt(0)
    v_mfma_f32_32x32x16_bf16 v[40:55], v[160:163], v[26:29], v[40:55]
    v_mfma_f32_32x32x16_bf16 v[72:87], v[160:163], v[30:33], v[72:87]
    v_mfma_f32_32x32x16_bf16 v[56:71], v[164:167], v[26:29], v[56:71]
    v_mfma_f32_32x32x16_bf16 v[88:103], v[164:167], v[30:33], v[88:103]
    s_setprio 2
    s_lshl_b32 s56, s52, 13
    s_add_u32 s56, s56, 81920
    v_bfe_u32 v2, v1, 1, 2
    v_lshlrev_b32 v2, 5, v2
    v_lshl_add_u32 v3, v16, 7, v2
    v_lshl_add_u32 v2, v1, 7, v2
    v_add_u32 v2, s56, v2
    v_add_u32 v3, s56, v3
    v_xor_b32 v8, 96, v3
    v_xor_b32 v3, 64, v3
    v_lshl_add_u32 v3, v17, 4, v3
    v_lshl_add_u32 v8, v17, 3, v8
    v_xor_b32 v9, 32, v2
    v_xor_b32 v10, 96, v2
LW_61:
    ds_read_b32 v25, v23 offset:60
    s_waitcnt lgkmcnt(0)
    v_readfirstlane_b32 s70, v25
    s_cmp_ge_u32 s70, 8
    s_cbranch_scc1 LD_62
    s_sleep 1
    s_sub_u32 s71, s71, 1
    s_cbranch_scc0 LW_61
    s_mov_b32 s71, 0
LD_62:
    v_cmp_eq_u32 vcc, 0, v17
    v_mov_b32 v11, 0x3f80
    v_cvt_pk_bf16_f32 v26, v60, v61
    v_cvt_pk_bf16_f32 v27, v62, v63
    v_cvt_pk_bf16_f32 v28, v64, v65
    v_cvt_pk_bf16_f32 v29, v66, v67
    v_cvt_pk_bf16_f32 v30, v68, v69
    v_cvt_pk_bf16_f32 v31, v70, v71
    v_cndmask_b32 v30, v11, v30, vcc
    v_cndmask_b32 v31, 0, v31, vcc
    ds_write_b128 v3, v[26:29] offset:0
    ds_write_b64 v8, v[30:31] offset:16
    v_cvt_pk_bf16_f32 v32, v92, v93
    v_cvt_pk_bf16_f32 v33, v94, v95
    v_cvt_pk_bf16_f32 v34, v96, v97
    v_cvt_pk_bf16_f32 v35, v98, v99
    v_cvt_pk_bf16_f32 v36, v100, v101
    v_cvt_pk_bf16_f32 v37, v102, v103
    v_cndmask_b32 v36, v11, v36, vcc
    v_cndmask_b32 v37, 0, v37, vcc
    ds_write_b128 v3, v[32:35] offset:4096
    ds_write_b64 v8, v[36:37] offset:4112
    v_permlane32_swap_b32 v68, v100
    s_nop 1
    v_mul_f32 v12, 0xbfb8aa3b, v100
    v_exp_f32 v12, v12
    s_nop 0
    v_add_f32 v12, 1.0, v12
    v_rcp_f32 v12, v12
    s_cmp_lg_u32 s52, 0
    s_cbranch_scc1 G_NOG
    v_lshlrev_b32 v13, 2, v1
    v_add_u32 v13, 163584, v13
    ds_write_b32 v13, v12
    s_waitcnt lgkmcnt(0)
G_NOG:
    s_mov_b64 exec, 1
    ds_add_u32 v23, v24 offset:120
    s_mov_b64 exec, -1
    v_max3_f32 v4, v40, v41, v42
    v_min3_f32 v6, v40, v41, v42
    v_max3_f32 v4, v4, v43, v44
    v_min3_f32 v6, v6, v43, v44
    v_max3_f32 v4, v4, v45, v46
    v_min3_f32 v6, v6, v45, v46
    v_max3_f32 v4, v4, v47, v48
    v_min3_f32 v6, v6, v47, v48
    v_max3_f32 v4, v4, v49, v50
    v_min3_f32 v6, v6, v49, v50
    v_max3_f32 v4, v4, v51, v52
    v_min3_f32 v6, v6, v51, v52
    v_max3_f32 v4, v4, v53, v54
    v_min3_f32 v6, v6, v53, v54
    v_max3_f32 v4, v4, v55, v56
    v_min3_f32 v6, v6, v55, v56
    v_max3_f32 v4, v4, v57, v58
    v_min3_f32 v6, v6, v57, v58
    v_max_f32 v4, v4, v59
    v_min_f32 v6, v6, v59
    v_mul_f32 v4, 0xbfb8aa3b, v4
    v_mul_f32 v6, s60, v6
    v_pk_fma_f32 v[104:105], v[40:41], s[60:61], v[4:5] op_sel_hi:[1,1,0]
    v_pk_fma_f32 v[124:125], v[40:41], s[60:61], v[6:7] op_sel_hi:[1,1,0] neg_lo:[1,0,0] neg_hi:[1,0,0]
    v_pk_fma_f32 v[106:107], v[42:43], s[60:61], v[4:5] op_sel_hi:[1,1,0]
    v_pk_fma_f32 v[126:127], v[42:43], s[60:61], v[6:7] op_sel_hi:[1,1,0] neg_lo:[1,0,0] neg_hi:[1,0,0]
    v_pk_fma_f32 v[108:109], v[44:45], s[60:61], v[4:5] op_sel_hi:[1,1,0]
    v_pk_fma_f32 v[128:129], v[44:45], s[60:61], v[6:7] op_sel_hi:[1,1,0] neg_lo:[1,0,0] neg_hi:[1,0,0]
    v_pk_fma_f32 v[110:111], v[46:47], s[60:61], v[4:5] op_sel_hi:[1,1,0]
    v_pk_fma_f32 v[130:131], v[46:47], s[60:61], v[6:7] op_sel_hi:[1,1,0] neg_lo:[1,0,0] neg_hi:[1,0,0]
    v_pk_fma_f32 v[112:113], v[48:49], s[60:61], v[4:5] op_sel_hi:[1,1,0]
    v_pk_fma_f32 v[132:133], v[48:49], s[60:61], v[6:7] op_sel_hi:[1,1,0] neg_lo:[1,0,0] neg_hi:[1,0,0]
    v_pk_fma_f32 v[114:115], v[50:51], s[60:61], v[4:5] op_sel_hi:[1,1,0]
    v_pk_fma_f32 v[134:135], v[50:51], s[60:61], v[6:7] op_sel_hi:[1,1,0] neg_lo:[1,0,0] neg_hi:[1,0,0]
    v_pk_fma_f32 v[116:117], v[52:53], s[60:61], v[4:5] op_sel_hi:[1,1,0]
    v_pk_fma_f32 v[136:137], v[52:53], s[60:61], v[6:7] op_sel_hi:[1,1,0] neg_lo:[1,0,0] neg_hi:[1,0,0]
    v_pk_fma_f32 v[118:119], v[54:55], s[60:61], v[4:5] op_sel_hi:[1,1,0]
    v_pk_fma_f32 v[138:139], v[54:55], s[60:61], v[6:7] op_sel_hi:[1,1,0] neg_lo:[1,0,0] neg_hi:[1,0,0]
    v_pk_fma_f32 v[120:121], v[56:57], s[60:61], v[4:5] op_sel_hi:[1,1,0]
    v_pk_fma_f32 v[140:141], v[56:57], s[60:61], v[6:7] op_sel_hi:[1,1,0] neg_lo:[1,0,0] neg_hi:[1,0,0]
    v_pk_fma_f32 v[122:123], v[58:59], s[60:61], v[4:5] op_sel_hi:[1,1,0]
    v_pk_fma_f32 v[142:143], v[58:59], s[60:61], v[6:7] op_sel_hi:[1,1,0] neg_lo:[1,0,0] neg_hi:[1,0,0]
    v_exp_f32 v104, v104
    v_exp_f32 v105, v105
    v_exp_f32 v106, v106
    v_exp_f32 v107, v107
    v_exp_f32 v108, v108
    v_exp_f32 v109, v109
    v_exp_f32 v110, v110
    v_exp_f32 v111, v111
    v_exp_f32 v112, v112
    v_exp_f32 v113, v113
    v_exp_f32 v114, v114
    v_exp_f32 v115, v115
    v_exp_f32 v116, v116
    v_exp_f32 v117, v117
    v_exp_f32 v118, v118
    v_exp_f32 v119, v119
    v_exp_f32 v120, v120
    v_exp_f32 v121, v121
    v_exp_f32 v122, v122
    v_exp_f32 v123, v123
    v_exp_f32 v124, v124
    v_exp_f32 v125, v125
    v_exp_f32 v126, v126
    v_exp_f32 v127, v127
    v_exp_f32 v128, v128
    v_exp_f32 v129, v129
    v_exp_f32 v130, v130
    v_exp_f32 v131, v131
    v_exp_f32 v132, v132
    v_exp_f32 v133, v133
    v_exp_f32 v134, v134
    v_exp_f32 v135, v135
    v_exp_f32 v136, v136
    v_exp_f32 v137, v137
    v_exp_f32 v138, v138
    v_exp_f32 v139, v139
    v_exp_f32 v140, v140
    v_exp_f32 v141, v141
    v_exp_f32 v142, v142
    v_exp_f32 v143, v143
    v_pk_add_f32 v[4:5], v[104:105], v[106:107]
    v_pk_add_f32 v[6:7], v[124:125], v[126:127]
    v_pk_add_f32 v[4:5], v[4:5], v[108:109]
    v_pk_add_f32 v[6:7], v[6:7], v[128:129]
    v_pk_add_f32 v[4:5], v[4:5], v[110:111]
    v_pk_add_f32 v[6:7], v[6:7], v[130:131]
    v_pk_add_f32 v[4:5], v[4:5], v[112:113]
    v_pk_add_f32 v[6:7], v[6:7], v[132:133]
    v_pk_add_f32 v[4:5], v[4:5], v[114:115]
    v_pk_add_f32 v[6:7], v[6:7], v[134:135]
    v_pk_add_f32 v[4:5], v[4:5], v[116:117]
    v_pk_add_f32 v[6:7], v[6:7], v[136:137]
    v_pk_add_f32 v[4:5], v[4:5], v[118:119]
    v_pk_add_f32 v[6:7], v[6:7], v[138:139]
    v_pk_add_f32 v[4:5], v[4:5], v[120:121]
    v_pk_add_f32 v[6:7], v[6:7], v[140:141]
    v_pk_add_f32 v[4:5], v[4:5], v[122:123]
    v_pk_add_f32 v[6:7], v[6:7], v[142:143]
    v_add_f32 v4, v4, v5
    v_add_f32 v6, v6, v7
    v_rcp_f32 v4, v4
    v_rcp_f32 v6, v6
    s_nop 0
    v_pk_mul_f32 v[104:105], v[104:105], v[4:5] op_sel_hi:[1,0]
    v_pk_mul_f32 v[124:125], v[124:125], v[6:7] op_sel_hi:[1,0]
    v_pk_mul_f32 v[106:107], v[106:107], v[4:5] op_sel_hi:[1,0]
    v_pk_mul_f32 v[126:127], v[126:127], v[6:7] op_sel_hi:[1,0]
    v_pk_mul_f32 v[108:109], v[108:109], v[4:5] op_sel_hi:[1,0]
    v_pk_mul_f32 v[128:129], v[128:129], v[6:7] op_sel_hi:[1,0]
    v_pk_mul_f32 v[110:111], v[110:111], v[4:5] op_sel_hi:[1,0]
    v_pk_mul_f32 v[130:131], v[130:131], v[6:7] op_sel_hi:[1,0]
    v_pk_mul_f32 v[112:113], v[112:113], v[4:5] op_sel_hi:[1,0]
    v_pk_mul_f32 v[132:133], v[132:133], v[6:7] op_sel_hi:[1,0]
    v_pk_mul_f32 v[114:115], v[114:115], v[4:5] op_sel_hi:[1,0]
    v_pk_mul_f32 v[134:135], v[134:135], v[6:7] op_sel_hi:[1,0]
    v_pk_mul_f32 v[116:117], v[116:117], v[4:5] op_sel_hi:[1,0]
    v_pk_mul_f32 v[136:137], v[136:137], v[6:7] op_sel_hi:[1,0]
    v_pk_mul_f32 v[118:119], v[118:119], v[4:5] op_sel_hi:[1,0]
    v_pk_mul_f32 v[138:139], v[138:139], v[6:7] op_sel_hi:[1,0]
    v_pk_mul_f32 v[120:121], v[120:121], v[4:5] op_sel_hi:[1,0]
    v_pk_mul_f32 v[140:141], v[140:141], v[6:7] op_sel_hi:[1,0]
    v_pk_mul_f32 v[122:123], v[122:123], v[4:5] op_sel_hi:[1,0]
    v_pk_mul_f32 v[142:143], v[142:143], v[6:7] op_sel_hi:[1,0]
    v_cvt_pk_bf16_f32 v144, v104, v105
    v_cvt_pk_bf16_f32 v145, v106, v107
    v_cvt_pk_bf16_f32 v146, v108, v109
    v_cvt_pk_bf16_f32 v147, v110, v111
    v_cvt_pk_bf16_f32 v148, v112, v113
    v_cvt_pk_bf16_f32 v149, v114, v115
    v_cvt_pk_bf16_f32 v150, v116, v117
    v_cvt_pk_bf16_f32 v151, v118, v119
    v_cvt_pk_bf16_f32 v152, v120, v121
    v_cvt_pk_bf16_f32 v153, v122, v123
    v_cvt_pk_bf16_f32 v154, v124, v125
    v_cvt_pk_bf16_f32 v155, v126, v127
    v_cvt_pk_bf16_f32 v156, v128, v129
    v_cvt_pk_bf16_f32 v157, v130, v131
    v_cvt_pk_bf16_f32 v158, v132, v133
    v_cvt_pk_bf16_f32 v159, v134, v135
    v_cvt_pk_bf16_f32 v160, v136, v137
    v_cvt_pk_bf16_f32 v161, v138, v139
    v_cvt_pk_bf16_f32 v162, v140, v141
    v_cvt_pk_bf16_f32 v163, v142, v143
    v_max3_f32 v4, v72, v73, v74
    v_min3_f32 v6, v72, v73, v74
    v_max3_f32 v4, v4, v75, v76
    v_min3_f32 v6, v6, v75, v76
    v_max3_f32 v4, v4, v77, v78
    v_min3_f32 v6, v6, v77, v78
    v_max3_f32 v4, v4, v79, v80
    v_min3_f32 v6, v6, v79, v80
    v_max3_f32 v4, v4, v81, v82
    v_min3_f32 v6, v6, v81, v82
    v_max3_f32 v4, v4, v83, v84
    v_min3_f32 v6, v6, v83, v84
    v_max3_f32 v4, v4, v85, v86
    v_min3_f32 v6, v6, v85, v86
    v_max3_f32 v4, v4, v87, v88
    v_min3_f32 v6, v6, v87, v88
    v_max3_f32 v4, v4, v89, v90
    v_min3_f32 v6, v6, v89, v90
    v_max_f32 v4, v4, v91
    v_min_f32 v6, v6, v91
    v_mul_f32 v4, 0xbfb8aa3b, v4
    v_mul_f32 v6, s60, v6
    v_pk_fma_f32 v[104:105], v[72:73], s[60:61], v[4:5] op_sel_hi:[1,1,0]
    v_pk_fma_f32 v[124:125], v[72:73], s[60:61], v[6:7] op_sel_hi:[1,1,0] neg_lo:[1,0,0] neg_hi:[1,0,0]
    v_pk_fma_f32 v[106:107], v[74:75], s[60:61], v[4:5] op_sel_hi:[1,1,0]
    v_pk_fma_f32 v[126:127], v[74:75], s[60:61], v[6:7] op_sel_hi:[1,1,0] neg_lo:[1,0,0] neg_hi:[1,0,0]
    v_pk_fma_f32 v[108:109], v[76:77], s[60:61], v[4:5] op_sel_hi:[1,1,0]
    v_pk_fma_f32 v[128:129], v[76:77], s[60:61], v[6:7] op_sel_hi:[1,1,0] neg_lo:[1,0,0] neg_hi:[1,0,0]
    v_pk_fma_f32 v[110:111], v[78:79], s[60:61], v[4:5] op_sel_hi:[1,1,0]
    v_pk_fma_f32 v[130:131], v[78:79], s[60:61], v[6:7] op_sel_hi:[1,1,0] neg_lo:[1,0,0] neg_hi:[1,0,0]
    v_pk_fma_f32 v[112:113], v[80:81], s[60:61], v[4:5] op_sel_hi:[1,1,0]
    v_pk_fma_f32 v[132:133], v[80:81], s[60:61], v[6:7] op_sel_hi:[1,1,0] neg_lo:[1,0,0] neg_hi:[1,0,0]
    v_pk_fma_f32 v[114:115], v[82:83], s[60:61], v[4:5] op_sel_hi:[1,1,0]
    v_pk_fma_f32 v[134:135], v[82:83], s[60:61], v[6:7] op_sel_hi:[1,1,0] neg_lo:[1,0,0] neg_hi:[1,0,0]
    v_pk_fma_f32 v[116:117], v[84:85], s[60:61], v[4:5] op_sel_hi:[1,1,0]
    v_pk_fma_f32 v[136:137], v[84:85], s[60:61], v[6:7] op_sel_hi:[1,1,0] neg_lo:[1,0,0] neg_hi:[1,0,0]
    v_pk_fma_f32 v[118:119], v[86:87], s[60:61], v[4:5] op_sel_hi:[1,1,0]
    v_pk_fma_f32 v[138:139], v[86:87], s[60:61], v[6:7] op_sel_hi:[1,1,0] neg_lo:[1,0,0] neg_hi:[1,0,0]
    v_pk_fma_f32 v[120:121], v[88:89], s[60:61], v[4:5] op_sel_hi:[1,1,0]
    v_pk_fma_f32 v[140:141], v[88:89], s[60:61], v[6:7] op_sel_hi:[1,1,0] neg_lo:[1,0,0] neg_hi:[1,0,0]
    v_pk_fma_f32 v[122:123], v[90:91], s[60:61], v[4:5] op_sel_hi:[1,1,0]
    v_pk_fma_f32 v[142:143], v[90:91], s[60:61], v[6:7] op_sel_hi:[1,1,0] neg_lo:[1,0,0] neg_hi:[1,0,0]
    v_exp_f32 v104, v104
    v_exp_f32 v105, v105
    v_exp_f32 v106, v106
    v_exp_f32 v107, v107
    v_exp_f32 v108, v108
    v_exp_f32 v109, v109
    v_exp_f32 v110, v110
    v_exp_f32 v111, v111
    v_exp_f32 v112, v112
    v_exp_f32 v113, v113
    v_exp_f32 v114, v114
    v_exp_f32 v115, v115
    v_exp_f32 v116, v116
    v_exp_f32 v117, v117
    v_exp_f32 v118, v118
    v_exp_f32 v119, v119
    v_exp_f32 v120, v120
    v_exp_f32 v121, v121
    v_exp_f32 v122, v122
    v_exp_f32 v123, v123
    v_exp_f32 v124, v124
    v_exp_f32 v125, v125
    v_exp_f32 v126, v126
    v_exp_f32 v127, v127
    v_exp_f32 v128, v128
    v_exp_f32 v129, v129
    v_exp_f32 v130, v130
    v_exp_f32 v131, v131
    v_exp_f32 v132, v132
    v_exp_f32 v133, v133
    v_exp_f32 v134, v134
    v_exp_f32 v135, v135
    v_exp_f32 v136, v136
    v_exp_f32 v137, v137
    v_exp_f32 v138, v138
    v_exp_f32 v139, v139
    v_exp_f32 v140, v140
    v_exp_f32 v141, v141
    v_exp_f32 v142, v142
    v_exp_f32 v143, v143
    v_pk_add_f32 v[4:5], v[104:105], v[106:107]
    v_pk_add_f32 v[6:7], v[124:125], v[126:127]
    v_pk_add_f32 v[4:5], v[4:5], v[108:109]
    v_pk_add_f32 v[6:7], v[6:7], v[128:129]
    v_pk_add_f32 v[4:5], v[4:5], v[110:111]
    v_pk_add_f32 v[6:7], v[6:7], v[130:131]
    v_pk_add_f32 v[4:5], v[4:5], v[112:113]
    v_pk_add_f32 v[6:7], v[6:7], v[132:133]
    v_pk_add_f32 v[4:5], v[4:5], v[114:115]
    v_pk_add_f32 v[6:7], v[6:7], v[134:135]
    v_pk_add_f32 v[4:5], v[4:5], v[116:117]
    v_pk_add_f32 v[6:7], v[6:7], v[136:137]
    v_pk_add_f32 v[4:5], v[4:5], v[118:119]
    v_pk_add_f32 v[6:7], v[6:7], v[138:139]
    v_pk_add_f32 v[4:5], v[4:5], v[120:121]
    v_pk_add_f32 v[6:7], v[6:7], v[140:141]
    v_pk_add_f32 v[4:5], v[4:5], v[122:123]
    v_pk_add_f32 v[6:7], v[6:7], v[142:143]
    v_add_f32 v4, v4, v5
    v_add_f32 v6, v6, v7
    v_rcp_f32 v4, v4
    v_rcp_f32 v6, v6
    s_nop 0
    v_pk_mul_f32 v[104:105], v[104:105], v[4:5] op_sel_hi:[1,0]
    v_pk_mul_f32 v[124:125], v[124:125], v[6:7] op_sel_hi:[1,0]
    v_pk_mul_f32 v[106:107], v[106:107], v[4:5] op_sel_hi:[1,0]
    v_pk_mul_f32 v[126:127], v[126:127], v[6:7] op_sel_hi:[1,0]
    v_pk_mul_f32 v[108:109], v[108:109], v[4:5] op_sel_hi:[1,0]
    v_pk_mul_f32 v[128:129], v[128:129], v[6:7] op_sel_hi:[1,0]
    v_pk_mul_f32 v[110:111], v[110:111], v[4:5] op_sel_hi:[1,0]
    v_pk_mul_f32 v[130:131], v[130:131], v[6:7] op_sel_hi:[1,0]
    v_pk_mul_f32 v[112:113], v[112:113], v[4:5] op_sel_hi:[1,0]
    v_pk_mul_f32 v[132:133], v[132:133], v[6:7] op_sel_hi:[1,0]
    v_pk_mul_f32 v[114:115], v[114:115], v[4:5] op_sel_hi:[1,0]
    v_pk_mul_f32 v[134:135], v[134:135], v[6:7] op_sel_hi:[1,0]
    v_pk_mul_f32 v[116:117], v[116:117], v[4:5] op_sel_hi:[1,0]
    v_pk_mul_f32 v[136:137], v[136:137], v[6:7] op_sel_hi:[1,0]
    v_pk_mul_f32 v[118:119], v[118:119], v[4:5] op_sel_hi:[1,0]
    v_pk_mul_f32 v[138:139], v[138:139], v[6:7] op_sel_hi:[1,0]
    v_pk_mul_f32 v[120:121], v[120:121], v[4:5] op_sel_hi:[1,0]
    v_pk_mul_f32 v[140:141], v[140:141], v[6:7] op_sel_hi:[1,0]
    v_pk_mul_f32 v[122:123], v[122:123], v[4:5] op_sel_hi:[1,0]
    v_pk_mul_f32 v[142:143], v[142:143], v[6:7] op_sel_hi:[1,0]
    v_cvt_pk_bf16_f32 v40, v104, v105
    v_cvt_pk_bf16_f32 v41, v106, v107
    v_cvt_pk_bf16_f32 v42, v108, v109
    v_cvt_pk_bf16_f32 v43, v110, v111
    v_cvt_pk_bf16_f32 v44, v112, v113
    v_cvt_pk_bf16_f32 v45, v114, v115
    v_cvt_pk_bf16_f32 v46, v116, v117
    v_cvt_pk_bf16_f32 v47, v118, v119
    v_cvt_pk_bf16_f32 v48, v120, v121
    v_cvt_pk_bf16_f32 v49, v122, v123
    v_cvt_pk_bf16_f32 v50, v124, v125
    v_cvt_pk_bf16_f32 v51, v126, v127
    v_cvt_pk_bf16_f32 v52, v128, v129
    v_cvt_pk_bf16_f32 v53, v130, v131
    v_cvt_pk_bf16_f32 v54, v132, v133
    v_cvt_pk_bf16_f32 v55, v134, v135
    v_cvt_pk_bf16_f32 v56, v136, v137
    v_cvt_pk_bf16_f32 v57, v138, v139
    v_cvt_pk_bf16_f32 v58, v140, v141
    v_cvt_pk_bf16_f32 v59, v142, v143
    s_nop 1
    v_permlane32_swap_b32 v144, v40
    v_permlane32_swap_b32 v145, v41
    v_permlane32_swap_b32 v146, v42
    v_permlane32_swap_b32 v147, v43
    v_permlane32_swap_b32 v148, v44
    v_permlane32_swap_b32 v149, v45
    v_permlane32_swap_b32 v150, v46
    v_permlane32_swap_b32 v151, v47
    v_permlane32_swap_b32 v152, v48
    v_permlane32_swap_b32 v153, v49
    v_permlane32_swap_b32 v154, v50
    v_permlane32_swap_b32 v155, v51
    v_permlane32_swap_b32 v156, v52
    v_permlane32_swap_b32 v157, v53
    v_permlane32_swap_b32 v158, v54
    v_permlane32_swap_b32 v159, v55
    v_permlane32_swap_b32 v160, v56
    v_permlane32_swap_b32 v161, v57
    v_permlane32_swap_b32 v162, v58
    v_permlane32_swap_b32 v163, v59
    s_nop 1
    ds_write_b128 v2, v[40:43]
    ds_write_b128 v2, v[44:47] offset:16
    ds_write_b128 v9, v[48:51]
    ds_write_b128 v9, v[52:55] offset:16
    ds_write_b128 v10, v[56:59]
    v_lshrrev_b32 v2, 2, v1
    v_bfe_u32 v3, v2, 1, 2
    v_lshlrev_b32 v3, 5, v3
    v_lshl_add_u32 v3, v2, 7, v3
    v_and_b32 v2, 3, v1
    v_lshl_add_u32 v2, v2, 3, v3
    v_add_u32 v2, s56, v2
    v_xor_b32 v3, 32, v2
    v_xor_b32 v4, 64, v2
    v_xor_b32 v5, 96, v2
    v_and_b32 v14, 15, v1
    v_lshrrev_b32 v15, 4, v1
    v_lshlrev_b32 v11, 4, v15
    v_lshl_add_u32 v8, v14, 6, v11
    v_lshl_add_u32 v11, v14, 5, v11
    s_lshl_b32 s56, s66, 5
    s_add_u32 s56, s56, s29
    s_mul_i32 s56, s56, 3360
    s_add_u32 s56, s56, 262144
    s_waitcnt lgkmcnt(0)
    ds_read_b64_tr_b16 v[64:65], v2 offset:0
    ds_read_b64_tr_b16 v[66:67], v2 offset:2048
    ds_read_b64_tr_b16 v[68:69], v3 offset:0
    ds_read_b64_tr_b16 v[70:71], v3 offset:2048
    ds_read_b64_tr_b16 v[72:73], v4 offset:0
    ds_read_b64_tr_b16 v[74:75], v4 offset:2048
    ds_read_b64_tr_b16 v[76:77], v5 offset:0
    ds_read_b64_tr_b16 v[78:79], v5 offset:2048
    ds_read_b64_tr_b16 v[80:81], v2 offset:4096
    ds_read_b64_tr_b16 v[82:83], v2 offset:6144
    ds_read_b64_tr_b16 v[84:85], v3 offset:4096
    ds_read_b64_tr_b16 v[86:87], v3 offset:6144
    ds_read_b64_tr_b16 v[88:89], v4 offset:4096
    ds_read_b64_tr_b16 v[90:91], v4 offset:6144
    ds_read_b64_tr_b16 v[92:93], v5 offset:4096
    ds_read_b64_tr_b16 v[94:95], v5 offset:6144
    s_waitcnt lgkmcnt(8)
    v_mfma_f32_16x16x32_bf16 v[104:107], v[64:67], v[72:75], 0
    v_mfma_f32_16x16x32_bf16 v[108:111], v[64:67], v[76:79], 0
    v_mfma_f32_16x16x32_bf16 v[112:115], v[68:71], v[72:75], 0
    v_mfma_f32_16x16x32_bf16 v[116:119], v[68:71], v[76:79], 0
    v_mfma_f32_16x16x32_bf16 v[120:123], v[76:79], v[72:75], 0
    v_mfma_f32_16x16x32_bf16 v[124:127], v[76:79], v[76:79], 0
    s_waitcnt lgkmcnt(0)
    v_mfma_f32_16x16x32_bf16 v[104:107], v[80:83], v[88:91], v[104:107]
    v_mfma_f32_16x16x32_bf16 v[108:111], v[80:83], v[92:95], v[108:111]
    v_mfma_f32_16x16x32_bf16 v[112:115], v[84:87], v[88:91], v[112:115]
    v_mfma_f32_16x16x32_bf16 v[116:119], v[84:87], v[92:95], v[116:119]
    v_mfma_f32_16x16x32_bf16 v[120:123], v[92:95], v[88:91], v[120:123]
    v_mfma_f32_16x16x32_bf16 v[124:127], v[92:95], v[92:95], v[124:127]
    s_lshl_b32 s57, s66, 9
    s_add_u32 s57, s57, 3801088
    v_lshlrev_b32 v9, 7, v1
    v_add_u32 v9, s57, v9
    s_and_b32 s58, s29, 3
    s_lshl_b32 s58, s58, 7
    s_add_u32 s57, s57, s58
    v_mov_b32 v10, s57
    buffer_store_dwordx4 v[104:107], v8, s[32:35], s56 offen offset:0 sc1
    buffer_store_dwordx4 v[112:115], v8, s[32:35], s56 offen offset:1344 sc1
    s_mov_b32 exec_lo, 0x1f001f00
    s_mov_b32 exec_hi, 0x1f001f00
    buffer_store_dwordx4 v[108:111], v8, s[32:35], s56 offen offset:512 sc1
    buffer_store_dwordx4 v[116:119], v8, s[32:35], s56 offen offset:1856 sc1
    s_mov_b32 exec_hi, 0
    buffer_store_dwordx4 v[124:127], v11, s[32:35], s56 offen offset:2944 sc1
    s_mov_b32 exec_lo, -1
    buffer_store_dwordx4 v[120:123], v11, s[32:35], s56 offen offset:2688 sc1
    s_mov_b64 exec, -1
    v_mov_b32 v18, -1
    v_mov_b32 v19, -1
    v_mov_b32 v20, -1
    v_mov_b32 v21, -1
    v_lshlrev_b32 v8, 3, v1
    v_mul_u32_u24 v22, 20480, v15
    v_lshl_add_u32 v22, v14, 4, v22
    s_lshr_b32 s56, s66, 1
    s_mul_i32 s56, s56, 5
    s_and_b32 s57, s66, 1
    s_lshl_b32 s58, s57, 1
    s_add_u32 s58, s58, s56
    s_lshl_b32 s58, s58, 8
    s_add_u32 s56, s56, 4
    s_lshl_b32 s56, s56, 8
    s_lshl_b32 s57, s57, 3
    s_add_u32 s56, s56, s57
    s_mul_i32 s57, s29, 81920
    s_add_u32 s57, s57, 8519680
    s_add_u32 s44, s58, s57
    s_add_u32 s45, s56, s57
    s_add_u32 s58, s44, 2621440
    s_add_u32 s59, s45, 2621440
    s_lshl_b32 s56, s66, 11
    s_mul_i32 s57, s29, 56
    s_add_u32 s56, s56, s57
    s_add_u32 s56, s56, 3735552
    s_waitcnt vmcnt(0)
    s_mov_b64 exec, 15
    buffer_atomic_add v24, v9, s[32:35], 0 offen offset:0 sc1
    s_mov_b64 exec, -1
    s_mov_b64 exec, 0x7f
    buffer_store_dwordx2 v[18:19], v8, s[32:35], s56 offen sc1
    s_mov_b64 exec, -1
    buffer_store_dwordx4 v[18:21], v22, s[32:35], s58 offen sc1
    buffer_store_dwordx4 v[18:21], v22, s[32:35], s58 offen offset:256 sc1
    buffer_store_dwordx2 v[18:19], v22, s[32:35], s59 offen sc1
    s_cmp_ge_u32 s29, 30
    s_cbranch_scc1 G_NORED
    s_lshl_b32 s56, s29, 2
    s_add_u32 s56, s56, s52
    s_cmp_ge_u32 s56, 60
    s_cselect_b32 s40, s18, s10
    s_cselect_b32 s41, s19, s11
    s_mov_b32 s42, 819200
    s_mov_b32 s43, 0x20000
    s_cselect_b32 s57, 60, 0
    s_cselect_b32 s64, 4, 8
    s_cselect_b32 s65, 8, 4
    s_mov_b32 s67, 6815744
    s_cselect_b32 s67, 7667712, s67
    s_sub_u32 s56, s56, s57
    s_mul_i32 s57, s56, 43
    s_lshr_b32 s57, s57, 7
    s_mul_i32 s58, s57, 3
    s_sub_u32 s58, s56, s58
    s_lshl_b32 s56, s57, 2
    v_lshrrev_b32 v2, 4, v16
    v_bfe_u32 v3, v16, 2, 1
    v_lshl_add_u32 v2, v2, 1, v3
    v_add_u32 v2, s56, v2
    v_mul_u32_u24 v3, 205, v2
    v_lshrrev_b32 v3, 10, v3
    v_mul_u32_u24 v4, 5, v3
    v_sub_u32 v4, v2, v4
    v_mul_u32_u24 v3, 40, v3
    v_and_b32 v5, 3, v16
    v_add_u32 v3, v3, v5
    v_bfe_u32 v5, v16, 3, 1
    v_lshrrev_b32 v6, 1, v4
    v_mul_u32_u24 v6, 20, v6
    v_and_b32 v7, 1, v4
    v_mul_u32_u24 v7, s64, v7
    v_mul_u32_u24 v8, s65, v5
    v_add3_u32 v6, v6, v7, v8
    v_mul_u32_u24 v7, 20, v5
    v_cmp_eq_u32 vcc, 4, v4
    v_add_u32 v7, 16, v7
    s_mul_i32 s56, s30, 160
    v_cndmask_b32 v6, v6, v7, vcc
    v_add_u32 v3, v3, v6
    v_mul_u32_u24 v3, 1280, v3
    v_lshl_add_u32 v3, v17, 4, v3
    s_lshl_b32 s64, s58, 6
    s_add_u32 s56, s56, s64
    buffer_load_dwordx4 v[48:51], v3, s[40:43], s56 offen
    buffer_load_dwordx4 v[52:55], v3, s[40:43], s56 offen offset:32
    s_lshl_b32 s58, s58, 5
    v_add_u32 v2, s58, v16
    v_mul_u32_u24 v5, 1280, v17
    v_lshl_add_u32 v5, v2, 4, v5
    v_cmp_gt_u32 vcc, 80, v2
    v_mov_b32 v6, 1073741824
    s_mul_i32 s56, s30, 20
    v_cndmask_b32 v5, v6, v5, vcc
    s_add_u32 s56, s56, s57
    s_mul_i32 s56, s56, 5120
    s_add_u32 s56, s56, s67
    v_and_b32 v6, 1, v1
    v_lshlrev_b32 v6, 4, v6
    v_mov_b32 v7, 0x3f80
    v_lshlrev_b32 v7, v6, v7
    v_lshrrev_b32 v8, 1, v16
    v_lshlrev_b32 v11, 2, v17
    v_sub_u32 v8, v8, v11
    v_cmp_eq_u32 s[88:89], 0, v8
    v_cmp_eq_u32 s[90:91], 1, v8
    v_cmp_eq_u32 s[92:93], 2, v8
    v_cmp_eq_u32 s[94:95], 3, v8
    s_nop 1
    v_cndmask_b32 v56, 0, v7, s[88:89]
    v_cndmask_b32 v57, 0, v7, s[90:91]
    v_cndmask_b32 v58, 0, v7, s[92:93]
    v_cndmask_b32 v59, 0, v7, s[94:95]
    v_cmp_eq_u32 s[88:89], 8, v8
    v_cmp_eq_u32 s[90:91], 9, v8
    v_cmp_eq_u32 s[92:93], 10, v8
    v_cmp_eq_u32 s[94:95], 11, v8
    s_nop 1
    v_cndmask_b32 v60, 0, v7, s[88:89]
    v_cndmask_b32 v61, 0, v7, s[90:91]
    v_cndmask_b32 v62, 0, v7, s[92:93]
    v_cndmask_b32 v63, 0, v7, s[94:95]
    s_waitcnt vmcnt(0)
    v_mfma_f32_32x32x16_bf16 v[64:79], v[48:51], v[56:59], 0
    v_mfma_f32_32x32x16_bf16 v[64:79], v[52:55], v[60:63], v[64:79]
    s_nop 11
    v_cvt_pk_bf16_f32 v80, v64, v65
    v_cvt_pk_bf16_f32 v81, v66, v67
    v_cvt_pk_bf16_f32 v82, v68, v69
    v_cvt_pk_bf16_f32 v83, v70, v71
    v_cvt_pk_bf16_f32 v84, v72, v73
    v_cvt_pk_bf16_f32 v85, v74, v75
    v_cvt_pk_bf16_f32 v86, v76, v77
    v_cvt_pk_bf16_f32 v87, v78, v79
    buffer_store_dwordx4 v[80:83], v5, s[32:35], s56 offen sc1
    buffer_store_dwordx4 v[84:87], v5, s[32:35], s56 offen offset:2560 sc1
    v_and_b32 v2, 7, v1
    v_lshrrev_b32 v3, 3, v1
    v_mul_u32_u24 v4, 13440, v2
    v_lshl_add_u32 v4, v3, 4, v4
    s_mul_i32 s56, s66, 107520
    s_mul_i32 s57, s29, 112
    s_add_u32 s56, s56, s57
    s_add_u32 s56, s56, 262144
    s_add_u32 s58, s56, 6720
    s_mov_b64 exec, 1
GP_63:
    buffer_load_dword v25, v10, s[32:35], 0 offen offset:0 sc1
    s_waitcnt vmcnt(0)
    v_cmp_gt_u32 vcc, 32, v25
    s_nop 1
    s_cmp_eq_u64 vcc, 0
    s_cbranch_scc1 GD_64
    s_sleep 8
    s_sub_u32 s71, s71, 1
    s_cbranch_scc0 GP_63
    s_mov_b32 s71, 0
GD_64:
    s_mov_b64 exec, -1
    s_mov_b32 exec_hi, 0x00ffffff
    buffer_load_dwordx4 v[64:67], v4, s[32:35], s56 offen sc1
    buffer_load_dwordx4 v[68:71], v4, s[32:35], s56 offen offset:3360 sc1
    buffer_load_dwordx4 v[72:75], v4, s[32:35], s58 offen sc1
    buffer_load_dwordx4 v[76:79], v4, s[32:35], s58 offen offset:3360 sc1
    s_waitcnt vmcnt(0)
    v_lshlrev_b32 v5, 3, v3
    s_lshl_b32 s56, s66, 11
    s_mul_i32 s57, s29, 56
    s_add_u32 s56, s56, s57
    s_add_u32 s56, s56, 3735552
    v_add_f32 v64, v64, v68
    v_add_f32 v72, v72, v76
    v_add_f32 v65, v65, v69
    v_add_f32 v73, v73, v77
    v_add_f32 v66, v66, v70
    v_add_f32 v74, v74, v78
    v_add_f32 v67, v67, v71
    v_add_f32 v75, v75, v79
    v_add_f32 v64, v64, v72
    v_add_f32 v65, v65, v73
    v_add_f32 v66, v66, v74
    v_add_f32 v67, v67, v75
    v_add_f32_dpp v64, v64, v64 quad_perm:[1,0,3,2] row_mask:0xf bank_mask:0xf
    v_add_f32_dpp v65, v65, v65 quad_perm:[1,0,3,2] row_mask:0xf bank_mask:0xf
    v_add_f32_dpp v66, v66, v66 quad_perm:[1,0,3,2] row_mask:0xf bank_mask:0xf
    v_add_f32_dpp v67, v67, v67 quad_perm:[1,0,3,2] row_mask:0xf bank_mask:0xf
    v_add_f32_dpp v64, v64, v64 quad_perm:[2,3,0,1] row_mask:0xf bank_mask:0xf
    v_add_f32_dpp v65, v65, v65 quad_perm:[2,3,0,1] row_mask:0xf bank_mask:0xf
    v_add_f32_dpp v66, v66, v66 quad_perm:[2,3,0,1] row_mask:0xf bank_mask:0xf
    v_add_f32_dpp v67, v67, v67 quad_perm:[2,3,0,1] row_mask:0xf bank_mask:0xf
    v_add_f32_dpp v64, v64, v64 row_half_mirror row_mask:0xf bank_mask:0xf
    v_add_f32_dpp v65, v65, v65 row_half_mirror row_mask:0xf bank_mask:0xf
    v_add_f32_dpp v66, v66, v66 row_half_mirror row_mask:0xf bank_mask:0xf
    v_add_f32_dpp v67, v67, v67 row_half_mirror row_mask:0xf bank_mask:0xf
    v_cvt_pk_bf16_f32 v68, v64, v65
    v_cvt_pk_bf16_f32 v69, v66, v67
    s_mov_b32 exec_lo, 0x01010101
    s_mov_b32 exec_hi, 0x00010101
    buffer_store_dwordx2 v[68:69], v5, s[32:35], s56 offen sc1
    s_mov_b64 exec, 15
    buffer_atomic_add v24, v9, s[32:35], s68 offen offset:0 sc1
    s_mov_b64 exec, -1
G_NORED:
    v_lshrrev_b32 v2, 3, v16
    v_and_b32 v3, 3, v16
    v_lshl_add_u32 v2, v2, 2, v3
    v_lshlrev_b32 v3, 5, v2
    v_bfe_u32 v4, v16, 2, 1
    v_cmp_eq_u32 vcc, v4, v17
    v_cmp_gt_u32 s[64:65], 5, v2
    v_mov_b32 v5, 1073741824
    v_cndmask_b32 v3, v5, v3, vcc
    s_lshl_b32 s56, s66, 11
    s_add_u32 s56, s56, 3735552
    v_cndmask_b32 v4, v5, v3, s[64:65]
    v_lshrrev_b32 v6, 1, v3
    v_lshrrev_b32 v7, 1, v4
    s_mov_b64 exec, 1
GP_65:
    buffer_load_dword v25, v10, s[32:35], s68 offen offset:0 sc1
    s_waitcnt vmcnt(0)
    v_cmp_gt_u32 vcc, 30, v25
    s_nop 1
    s_cmp_eq_u64 vcc, 0
    s_cbranch_scc1 GD_66
    s_sleep 8
    s_sub_u32 s71, s71, 1
    s_cbranch_scc0 GP_65
    s_mov_b32 s71, 0
GD_66:
    s_mov_b64 exec, -1
    s_mov_b64 exec, 1
    ds_add_u32 v23, v24 offset:52
    s_mov_b64 exec, -1
DP_67:
    buffer_load_dwordx4 v[64:67], v3, s[32:35], s56 offen offset:0 sc1
    buffer_load_dwordx4 v[68:71], v4, s[32:35], s56 offen offset:512 sc1
    buffer_load_dwordx4 v[72:75], v3, s[32:35], s56 offen offset:16 sc1
    buffer_load_dwordx4 v[76:79], v4, s[32:35], s56 offen offset:528 sc1
    buffer_load_dwordx4 v[80:83], v3, s[32:35], s56 offen offset:672 sc1
    buffer_load_dwordx4 v[84:87], v4, s[32:35], s56 offen offset:1184 sc1
    buffer_load_dwordx4 v[88:91], v3, s[32:35], s56 offen offset:688 sc1
    buffer_load_dwordx4 v[92:95], v4, s[32:35], s56 offen offset:1200 sc1
    buffer_load_dwordx4 v[96:99], v6, s[32:35], s56 offen offset:1344 sc1
    buffer_load_dwordx4 v[100:103], v7, s[32:35], s56 offen offset:1600 sc1
    s_waitcnt vmcnt(0)
    v_max3_u32 v25, v64, v65, v66
    v_max3_u32 v18, v67, v68, v69
    v_max3_u32 v25, v25, v70, v71
    v_max3_u32 v18, v18, v72, v73
    v_max3_u32 v25, v25, v74, v75
    v_max3_u32 v18, v18, v76, v77
    v_max3_u32 v25, v25, v78, v79
    v_max3_u32 v18, v18, v80, v81
    v_max3_u32 v25, v25, v82, v83
    v_max3_u32 v18, v18, v84, v85
    v_max3_u32 v25, v25, v86, v87
    v_max3_u32 v18, v18, v88, v89
    v_max3_u32 v25, v25, v90, v91
    v_max3_u32 v18, v18, v92, v93
    v_max3_u32 v25, v25, v94, v95
    v_max3_u32 v18, v18, v96, v97
    v_max3_u32 v25, v25, v98, v99
    v_max3_u32 v18, v18, v100, v101
    v_max3_u32 v25, v25, v102, v103
    v_max_u32 v25, v25, v18
    v_cmp_eq_u32 vcc, -1, v25
    s_nop 1
    s_cmp_eq_u64 vcc, 0
    s_cbranch_scc1 DD_68
    s_sleep 2
    s_sub_u32 s71, s71, 1
    s_cbranch_scc0 DP_67
    s_mov_b32 s71, 0
DD_68:
    v_mfma_f32_32x32x16_bf16 v[104:119], v[64:67], v[144:147], 0
    v_mfma_f32_32x32x16_bf16 v[120:135], v[68:71], v[144:147], 0
    v_mfma_f32_32x32x16_bf16 v[104:119], v[72:75], v[148:151], v[104:119]
    v_mfma_f32_32x32x16_bf16 v[120:135], v[76:79], v[148:151], v[120:135]
    v_mfma_f32_32x32x16_bf16 v[104:119], v[80:83], v[152:155], v[104:119]
    v_mfma_f32_32x32x16_bf16 v[120:135], v[84:87], v[152:155], v[120:135]
    v_mfma_f32_32x32x16_bf16 v[104:119], v[88:91], v[156:159], v[104:119]
    v_mfma_f32_32x32x16_bf16 v[120:135], v[92:95], v[156:159], v[120:135]
    v_mfma_f32_32x32x16_bf16 v[104:119], v[96:99], v[160:163], v[104:119]
    v_mfma_f32_32x32x16_bf16 v[120:135], v[100:103], v[160:163], v[120:135]
    s_lshl_b32 s57, s29, 7
    s_add_u32 s57, s57, 3833856
    v_mov_b32 v9, s57
    s_nop 8
    v_add_f32 v4, 0x358637bd, v124
    v_rcp_f32 v4, v4
    s_nop 0
    v_mul_f32 v4, v4, v12
    v_pk_mul_f32 v[104:105], v[104:105], v[4:5] op_sel_hi:[1,0]
    v_pk_mul_f32 v[106:107], v[106:107], v[4:5] op_sel_hi:[1,0]
    v_pk_mul_f32 v[108:109], v[108:109], v[4:5] op_sel_hi:[1,0]
    v_pk_mul_f32 v[110:111], v[110:111], v[4:5] op_sel_hi:[1,0]
    v_pk_mul_f32 v[112:113], v[112:113], v[4:5] op_sel_hi:[1,0]
    v_pk_mul_f32 v[114:115], v[114:115], v[4:5] op_sel_hi:[1,0]
    v_pk_mul_f32 v[116:117], v[116:117], v[4:5] op_sel_hi:[1,0]
    v_pk_mul_f32 v[118:119], v[118:119], v[4:5] op_sel_hi:[1,0]
    v_pk_mul_f32 v[120:121], v[120:121], v[4:5] op_sel_hi:[1,0]
    v_pk_mul_f32 v[122:123], v[122:123], v[4:5] op_sel_hi:[1,0]
    v_cvt_pk_bf16_f32 v64, v104, v105
    v_cvt_pk_bf16_f32 v65, v106, v107
    v_cvt_pk_bf16_f32 v66, v108, v109
    v_cvt_pk_bf16_f32 v67, v110, v111
    v_cvt_pk_bf16_f32 v68, v112, v113
    v_cvt_pk_bf16_f32 v69, v114, v115
    v_cvt_pk_bf16_f32 v70, v116, v117
    v_cvt_pk_bf16_f32 v71, v118, v119
    v_cvt_pk_bf16_f32 v72, v120, v121
    v_cvt_pk_bf16_f32 v73, v122, v123
    buffer_store_dwordx4 v[64:67], v22, s[32:35], s44 offen sc1
    buffer_store_dwordx4 v[68:71], v22, s[32:35], s44 offen offset:256 sc1
    buffer_store_dwordx2 v[72:73], v22, s[32:35], s45 offen sc1
    v_lshlrev_b32 v2, 4, v1
    s_mul_i32 s53, s30, 102400
    s_add_u32 s53, s53, 6815744
LW_69:
    ds_read_b32 v25, v23 offset:52
    s_waitcnt lgkmcnt(0)
    v_readfirstlane_b32 s70, v25
    s_cmp_ge_u32 s70, 4
    s_cbranch_scc1 LD_70
    s_sleep 1
    s_sub_u32 s71, s71, 1
    s_cbranch_scc0 LW_69
    s_mov_b32 s71, 0
LD_70:
    s_mul_i32 s56, s52, 25600
    s_add_u32 s57, s53, s56
    s_add_u32 s57, s57, 0
    s_add_u32 m0, s56, 0
    s_nop 0
    buffer_load_dwordx4 v2, s[32:35], s57 offen offset:0 sc1 lds
    buffer_load_dwordx4 v2, s[32:35], s57 offen offset:1024 sc1 lds
    buffer_load_dwordx4 v2, s[32:35], s57 offen offset:2048 sc1 lds
    buffer_load_dwordx4 v2, s[32:35], s57 offen offset:3072 sc1 lds
    s_add_u32 s57, s57, 4096
    s_add_u32 m0, s56, 4096
    s_nop 0
    buffer_load_dwordx4 v2, s[32:35], s57 offen offset:0 sc1 lds
    buffer_load_dwordx4 v2, s[32:35], s57 offen offset:1024 sc1 lds
    buffer_load_dwordx4 v2, s[32:35], s57 offen offset:2048 sc1 lds
    buffer_load_dwordx4 v2, s[32:35], s57 offen offset:3072 sc1 lds
    s_add_u32 s57, s57, 4096
    s_waitcnt vmcnt(8)
    s_mov_b64 exec, 1
    buffer_atomic_add v24, v9, s[32:35], 0 offen offset:0 sc1
    s_mov_b64 exec, -1
    s_waitcnt vmcnt(4)
    s_add_u32 m0, s56, 8192
    s_nop 0
    buffer_load_dwordx4 v2, s[32:35], s57 offen offset:0 sc1 lds
    buffer_load_dwordx4 v2, s[32:35], s57 offen offset:1024 sc1 lds
    buffer_load_dwordx4 v2, s[32:35], s57 offen offset:2048 sc1 lds
    buffer_load_dwordx4 v2, s[32:35], s57 offen offset:3072 sc1 lds
    s_add_u32 s57, s57, 4096
    s_waitcnt vmcnt(4)
    s_add_u32 m0, s56, 12288
    s_nop 0
    buffer_load_dwordx4 v2, s[32:35], s57 offen offset:0 sc1 lds
    buffer_load_dwordx4 v2, s[32:35], s57 offen offset:1024 sc1 lds
    buffer_load_dwordx4 v2, s[32:35], s57 offen offset:2048 sc1 lds
    buffer_load_dwordx4 v2, s[32:35], s57 offen offset:3072 sc1 lds
    s_add_u32 s57, s57, 4096
    s_waitcnt vmcnt(4)
    s_add_u32 m0, s56, 16384
    s_nop 0
    buffer_load_dwordx4 v2, s[32:35], s57 offen offset:0 sc1 lds
    buffer_load_dwordx4 v2, s[32:35], s57 offen offset:1024 sc1 lds
    buffer_load_dwordx4 v2, s[32:35], s57 offen offset:2048 sc1 lds
    buffer_load_dwordx4 v2, s[32:35], s57 offen offset:3072 sc1 lds
    s_add_u32 s57, s57, 4096
    s_waitcnt vmcnt(4)
    s_add_u32 m0, s56, 20480
    s_nop 0
    buffer_load_dwordx4 v2, s[32:35], s57 offen offset:0 sc1 lds
    buffer_load_dwordx4 v2, s[32:35], s57 offen offset:1024 sc1 lds
    buffer_load_dwordx4 v2, s[32:35], s57 offen offset:2048 sc1 lds
    buffer_load_dwordx4 v2, s[32:35], s57 offen offset:3072 sc1 lds
    s_add_u32 s57, s57, 4096
    s_waitcnt vmcnt(4)
    s_add_u32 m0, s56, 24576
    s_nop 0
    buffer_load_dwordx4 v2, s[32:35], s57 offen offset:0 sc1 lds
    s_and_b32 s56, s29, 3
    s_lshl_b32 s56, s56, 2
    s_add_u32 s56, s56, s52
    s_mul_i32 s56, s56, 6400
    s_add_u32 s56, s56, s53
    s_add_u32 s56, s56, 851968
    v_lshlrev_b32 v3, 7, v1
    s_mov_b32 exec_hi, 0x3ffff
    buffer_load_dword v18, v3, s[32:35], s56 offen sc1
    s_mov_b64 exec, -1
    v_mov_b32 v26, 0
    v_mov_b32 v27, 0
    v_mov_b32 v28, 0
    v_mov_b32 v29, 0
    v_mov_b32 v30, 0
    v_mov_b32 v31, 0
    v_mov_b32 v32, 0
    v_mov_b32 v33, 0
    v_mov_b32 v34, 0
    v_mov_b32 v35, 0
    v_mov_b32 v36, 0
    v_mov_b32 v37, 0
    v_mov_b32 v38, 0
    v_mov_b32 v39, 0
    v_mov_b32 v40, 0
    v_mov_b32 v41, 0
    v_mov_b32 v42, 0
    v_mov_b32 v43, 0
    v_mov_b32 v44, 0
    v_mov_b32 v45, 0
    v_mul_u32_u24 v4, 1280, v15
    v_lshrrev_b32 v5, 2, v14
    v_mul_u32_u24 v5, 320, v5
    v_and_b32 v3, 3, v14
    v_lshl_add_u32 v3, v3, 4, v5
    v_add_u32 v4, v4, v3
    v_add_u32 v5, 51200, v4
    s_lshl_b32 s54, s29, 2
    s_add_u32 s54, s54, s52
    s_mul_i32 s54, s54, 20480
    s_add_u32 s54, s54, 8519680
    s_mov_b32 s55, 8
    s_mov_b32 s64, 32
    s_mov_b32 s65, 0
    s_mov_b32 s67, 0
    s_setprio 0
    s_waitcnt vmcnt(0)
G_PASS:
    s_mov_b64 exec, 1
    ds_add_u32 v23, v24 offset:52
    s_mov_b64 exec, -1
    v_mov_b32 v6, 163380
    s_branch G_P1
G_PASS2:
LW_71:
    ds_read_b32 v25, v23 offset:116
    s_waitcnt lgkmcnt(0)
    v_readfirstlane_b32 s70, v25
    s_cmp_ge_u32 s70, 8
    s_cbranch_scc1 LD_72
    s_sleep 2
    s_sub_u32 s71, s71, 1
    s_cbranch_scc0 LW_71
    s_mov_b32 s71, 0
LD_72:
    s_setprio 3
G_P1:
    s_add_u32 s67, s67, 1
    s_cmp_lg_u32 s52, 0
    s_cbranch_scc1 G_P2
    s_mov_b64 exec, 1
GP_73:
    buffer_load_dword v25, v9, s[32:35], s65 offen offset:0 sc1
    s_waitcnt vmcnt(0)
    v_cmp_gt_u32 vcc, s64, v25
    s_nop 1
    s_cmp_eq_u64 vcc, 0
    s_cbranch_scc1 GD_74
    s_sleep 4
    s_sub_u32 s71, s71, 1
    s_cbranch_scc0 GP_73
    s_mov_b32 s71, 0
GD_74:
    s_mov_b64 exec, -1
    s_mov_b64 exec, 1
    ds_add_u32 v23, v24 offset:172
    s_mov_b64 exec, -1
G_P2:
LW_75:
    ds_read_b32 v25, v23 offset:172
    s_waitcnt lgkmcnt(0)
    v_readfirstlane_b32 s70, v25
    s_cmp_ge_u32 s70, s67
    s_cbranch_scc1 LD_76
    s_sleep 1
    s_sub_u32 s71, s71, 1
    s_cbranch_scc0 LW_75
    s_mov_b32 s71, 0
LD_76:
    s_add_u32 s88, s54, 0
    s_add_u32 s89, s54, 4096
    s_add_u32 s90, s54, 8192
    s_add_u32 s91, s54, 12288
    s_add_u32 s92, s54, 16384
    buffer_load_dwordx4 v[88:91], v2, s[32:35], s88 offen offset:0 sc1
    buffer_load_dwordx4 v[92:95], v2, s[32:35], s88 offen offset:1024 sc1
    buffer_load_dwordx4 v[96:99], v2, s[32:35], s88 offen offset:2048 sc1
    buffer_load_dwordx4 v[100:103], v2, s[32:35], s88 offen offset:3072 sc1
    buffer_load_dwordx4 v[104:107], v2, s[32:35], s89 offen offset:0 sc1
    buffer_load_dwordx4 v[108:111], v2, s[32:35], s89 offen offset:1024 sc1
    buffer_load_dwordx4 v[112:115], v2, s[32:35], s89 offen offset:2048 sc1
    buffer_load_dwordx4 v[116:119], v2, s[32:35], s89 offen offset:3072 sc1
    buffer_load_dwordx4 v[120:123], v2, s[32:35], s90 offen offset:0 sc1
    buffer_load_dwordx4 v[124:127], v2, s[32:35], s90 offen offset:1024 sc1
    buffer_load_dwordx4 v[128:131], v2, s[32:35], s90 offen offset:2048 sc1
    buffer_load_dwordx4 v[132:135], v2, s[32:35], s90 offen offset:3072 sc1
    buffer_load_dwordx4 v[136:139], v2, s[32:35], s91 offen offset:0 sc1
    buffer_load_dwordx4 v[140:143], v2, s[32:35], s91 offen offset:1024 sc1
    buffer_load_dwordx4 v[144:147], v2, s[32:35], s91 offen offset:2048 sc1
    buffer_load_dwordx4 v[148:151], v2, s[32:35], s91 offen offset:3072 sc1
    buffer_load_dwordx4 v[152:155], v2, s[32:35], s92 offen offset:0 sc1
    buffer_load_dwordx4 v[156:159], v2, s[32:35], s92 offen offset:1024 sc1
    buffer_load_dwordx4 v[160:163], v2, s[32:35], s92 offen offset:2048 sc1
    buffer_load_dwordx4 v[164:167], v2, s[32:35], s92 offen offset:3072 sc1
LW_77:
    ds_read_b32 v25, v6 offset:0
    s_waitcnt lgkmcnt(0)
    v_readfirstlane_b32 s70, v25
    s_cmp_ge_u32 s70, 8
    s_cbranch_scc1 LD_78
    s_sleep 1
    s_sub_u32 s71, s71, 1
    s_cbranch_scc0 LW_77
    s_mov_b32 s71, 0
LD_78:
    ds_read_b128 v[48:51], v4 offset:0
    ds_read_b128 v[52:55], v4 offset:64
    ds_read_b128 v[56:59], v4 offset:128
    ds_read_b128 v[60:63], v4 offset:192
    ds_read_b128 v[64:67], v4 offset:256
    ds_read_b128 v[68:71], v4 offset:5120
    ds_read_b128 v[72:75], v4 offset:5184
    ds_read_b128 v[76:79], v4 offset:5248
    ds_read_b128 v[80:83], v4 offset:5312
    ds_read_b128 v[84:87], v4 offset:5376
    s_waitcnt vmcnt(16)
G_OC_79:
    v_max3_u32 v18, v88, v89, v90
    v_max3_u32 v19, v91, v92, v93
    v_max3_u32 v18, v18, v94, v95
    v_max3_u32 v19, v19, v96, v97
    v_max3_u32 v18, v18, v98, v99
    v_max3_u32 v19, v19, v100, v101
    v_max3_u32 v18, v18, v102, v103
    v_max_u32 v18, v18, v19
    v_cmp_eq_u32 vcc, -1, v18
    s_nop 1
    s_cmp_eq_u64 vcc, 0
    s_cbranch_scc0 G_OS_80
G_OB_81:
    s_waitcnt lgkmcnt(5)
    v_mfma_f32_16x16x32_bf16 v[26:29], v[48:51], v[88:91], v[26:29]
    v_mfma_f32_16x16x32_bf16 v[30:33], v[52:55], v[88:91], v[30:33]
    v_mfma_f32_16x16x32_bf16 v[34:37], v[56:59], v[88:91], v[34:37]
    v_mfma_f32_16x16x32_bf16 v[38:41], v[60:63], v[88:91], v[38:41]
    v_mfma_f32_16x16x32_bf16 v[42:45], v[64:67], v[88:91], v[42:45]
    ds_read_b128 v[48:51], v4 offset:10240
    ds_read_b128 v[52:55], v4 offset:10304
    ds_read_b128 v[56:59], v4 offset:10368
    ds_read_b128 v[60:63], v4 offset:10432
    ds_read_b128 v[64:67], v4 offset:10496
    s_waitcnt lgkmcnt(5)
    v_mfma_f32_16x16x32_bf16 v[26:29], v[68:71], v[92:95], v[26:29]
    v_mfma_f32_16x16x32_bf16 v[30:33], v[72:75], v[92:95], v[30:33]
    v_mfma_f32_16x16x32_bf16 v[34:37], v[76:79], v[92:95], v[34:37]
    v_mfma_f32_16x16x32_bf16 v[38:41], v[80:83], v[92:95], v[38:41]
    v_mfma_f32_16x16x32_bf16 v[42:45], v[84:87], v[92:95], v[42:45]
    ds_read_b128 v[68:71], v4 offset:15360
    ds_read_b128 v[72:75], v4 offset:15424
    ds_read_b128 v[76:79], v4 offset:15488
    ds_read_b128 v[80:83], v4 offset:15552
    ds_read_b128 v[84:87], v4 offset:15616
    s_waitcnt lgkmcnt(5)
    v_mfma_f32_16x16x32_bf16 v[26:29], v[48:51], v[96:99], v[26:29]
    v_mfma_f32_16x16x32_bf16 v[30:33], v[52:55], v[96:99], v[30:33]
    v_mfma_f32_16x16x32_bf16 v[34:37], v[56:59], v[96:99], v[34:37]
    v_mfma_f32_16x16x32_bf16 v[38:41], v[60:63], v[96:99], v[38:41]
    v_mfma_f32_16x16x32_bf16 v[42:45], v[64:67], v[96:99], v[42:45]
    ds_read_b128 v[48:51], v4 offset:20480
    ds_read_b128 v[52:55], v4 offset:20544
    ds_read_b128 v[56:59], v4 offset:20608
    ds_read_b128 v[60:63], v4 offset:20672
    ds_read_b128 v[64:67], v4 offset:20736
    s_waitcnt lgkmcnt(5)
    v_mfma_f32_16x16x32_bf16 v[26:29], v[68:71], v[100:103], v[26:29]
    v_mfma_f32_16x16x32_bf16 v[30:33], v[72:75], v[100:103], v[30:33]
    v_mfma_f32_16x16x32_bf16 v[34:37], v[76:79], v[100:103], v[34:37]
    v_mfma_f32_16x16x32_bf16 v[38:41], v[80:83], v[100:103], v[38:41]
    v_mfma_f32_16x16x32_bf16 v[42:45], v[84:87], v[100:103], v[42:45]
    ds_read_b128 v[68:71], v4 offset:25600
    ds_read_b128 v[72:75], v4 offset:25664
    ds_read_b128 v[76:79], v4 offset:25728
    ds_read_b128 v[80:83], v4 offset:25792
    ds_read_b128 v[84:87], v4 offset:25856
    s_waitcnt vmcnt(12)
G_OC_82:
    v_max3_u32 v18, v104, v105, v106
    v_max3_u32 v19, v107, v108, v109
    v_max3_u32 v18, v18, v110, v111
    v_max3_u32 v19, v19, v112, v113
    v_max3_u32 v18, v18, v114, v115
    v_max3_u32 v19, v19, v116, v117
    v_max3_u32 v18, v18, v118, v119
    v_max_u32 v18, v18, v19
    v_cmp_eq_u32 vcc, -1, v18
    s_nop 1
    s_cmp_eq_u64 vcc, 0
    s_cbranch_scc0 G_OS_83
G_OB_84:
    s_waitcnt lgkmcnt(5)
    v_mfma_f32_16x16x32_bf16 v[26:29], v[48:51], v[104:107], v[26:29]
    v_mfma_f32_16x16x32_bf16 v[30:33], v[52:55], v[104:107], v[30:33]
    v_mfma_f32_16x16x32_bf16 v[34:37], v[56:59], v[104:107], v[34:37]
    v_mfma_f32_16x16x32_bf16 v[38:41], v[60:63], v[104:107], v[38:41]
    v_mfma_f32_16x16x32_bf16 v[42:45], v[64:67], v[104:107], v[42:45]
    ds_read_b128 v[48:51], v4 offset:30720
    ds_read_b128 v[52:55], v4 offset:30784
    ds_read_b128 v[56:59], v4 offset:30848
    ds_read_b128 v[60:63], v4 offset:30912
    ds_read_b128 v[64:67], v4 offset:30976
    s_waitcnt lgkmcnt(5)
    v_mfma_f32_16x16x32_bf16 v[26:29], v[68:71], v[108:111], v[26:29]
    v_mfma_f32_16x16x32_bf16 v[30:33], v[72:75], v[108:111], v[30:33]
    v_mfma_f32_16x16x32_bf16 v[34:37], v[76:79], v[108:111], v[34:37]
    v_mfma_f32_16x16x32_bf16 v[38:41], v[80:83], v[108:111], v[38:41]
    v_mfma_f32_16x16x32_bf16 v[42:45], v[84:87], v[108:111], v[42:45]
    ds_read_b128 v[68:71], v4 offset:35840
    ds_read_b128 v[72:75], v4 offset:35904
    ds_read_b128 v[76:79], v4 offset:35968
    ds_read_b128 v[80:83], v4 offset:36032
    ds_read_b128 v[84:87], v4 offset:36096
    s_waitcnt lgkmcnt(5)
    v_mfma_f32_16x16x32_bf16 v[26:29], v[48:51], v[112:115], v[26:29]
    v_mfma_f32_16x16x32_bf16 v[30:33], v[52:55], v[112:115], v[30:33]
    v_mfma_f32_16x16x32_bf16 v[34:37], v[56:59], v[112:115], v[34:37]
    v_mfma_f32_16x16x32_bf16 v[38:41], v[60:63], v[112:115], v[38:41]
    v_mfma_f32_16x16x32_bf16 v[42:45], v[64:67], v[112:115], v[42:45]
    ds_read_b128 v[48:51], v4 offset:40960
    ds_read_b128 v[52:55], v4 offset:41024
    ds_read_b128 v[56:59], v4 offset:41088
    ds_read_b128 v[60:63], v4 offset:41152
    ds_read_b128 v[64:67], v4 offset:41216
    s_waitcnt lgkmcnt(5)
    v_mfma_f32_16x16x32_bf16 v[26:29], v[68:71], v[116:119], v[26:29]
    v_mfma_f32_16x16x32_bf16 v[30:33], v[72:75], v[116:119], v[30:33]
    v_mfma_f32_16x16x32_bf16 v[34:37], v[76:79], v[116:119], v[34:37]
    v_mfma_f32_16x16x32_bf16 v[38:41], v[80:83], v[116:119], v[38:41]
    v_mfma_f32_16x16x32_bf16 v[42:45], v[84:87], v[116:119], v[42:45]
    ds_read_b128 v[68:71], v4 offset:46080
    ds_read_b128 v[72:75], v4 offset:46144
    ds_read_b128 v[76:79], v4 offset:46208
    ds_read_b128 v[80:83], v4 offset:46272
    ds_read_b128 v[84:87], v4 offset:46336
    s_waitcnt vmcnt(8)
G_OC_85:
    v_max3_u32 v18, v120, v121, v122
    v_max3_u32 v19, v123, v124, v125
    v_max3_u32 v18, v18, v126, v127
    v_max3_u32 v19, v19, v128, v129
    v_max3_u32 v18, v18, v130, v131
    v_max3_u32 v19, v19, v132, v133
    v_max3_u32 v18, v18, v134, v135
    v_max_u32 v18, v18, v19
    v_cmp_eq_u32 vcc, -1, v18
    s_nop 1
    s_cmp_eq_u64 vcc, 0
    s_cbranch_scc0 G_OS_86
G_OB_87:
    s_waitcnt lgkmcnt(5)
    v_mfma_f32_16x16x32_bf16 v[26:29], v[48:51], v[120:123], v[26:29]
    v_mfma_f32_16x16x32_bf16 v[30:33], v[52:55], v[120:123], v[30:33]
    v_mfma_f32_16x16x32_bf16 v[34:37], v[56:59], v[120:123], v[34:37]
    v_mfma_f32_16x16x32_bf16 v[38:41], v[60:63], v[120:123], v[38:41]
    v_mfma_f32_16x16x32_bf16 v[42:45], v[64:67], v[120:123], v[42:45]
    ds_read_b128 v[48:51], v5 offset:0
    ds_read_b128 v[52:55], v5 offset:64
    ds_read_b128 v[56:59], v5 offset:128
    ds_read_b128 v[60:63], v5 offset:192
    ds_read_b128 v[64:67], v5 offset:256
    s_waitcnt lgkmcnt(5)
    v_mfma_f32_16x16x32_bf16 v[26:29], v[68:71], v[124:127], v[26:29]
    v_mfma_f32_16x16x32_bf16 v[30:33], v[72:75], v[124:127], v[30:33]
    v_mfma_f32_16x16x32_bf16 v[34:37], v[76:79], v[124:127], v[34:37]
    v_mfma_f32_16x16x32_bf16 v[38:41], v[80:83], v[124:127], v[38:41]
    v_mfma_f32_16x16x32_bf16 v[42:45], v[84:87], v[124:127], v[42:45]
    ds_read_b128 v[68:71], v5 offset:5120
    ds_read_b128 v[72:75], v5 offset:5184
    ds_read_b128 v[76:79], v5 offset:5248
    ds_read_b128 v[80:83], v5 offset:5312
    ds_read_b128 v[84:87], v5 offset:5376
    s_waitcnt lgkmcnt(5)
    s_mov_b64 exec, 1
    ds_add_u32 v23, v24 offset:184
    s_mov_b64 exec, -1
    v_mfma_f32_16x16x32_bf16 v[26:29], v[48:51], v[128:131], v[26:29]
    v_mfma_f32_16x16x32_bf16 v[30:33], v[52:55], v[128:131], v[30:33]
    v_mfma_f32_16x16x32_bf16 v[34:37], v[56:59], v[128:131], v[34:37]
    v_mfma_f32_16x16x32_bf16 v[38:41], v[60:63], v[128:131], v[38:41]
    v_mfma_f32_16x16x32_bf16 v[42:45], v[64:67], v[128:131], v[42:45]
    ds_read_b128 v[48:51], v5 offset:10240
    ds_read_b128 v[52:55], v5 offset:10304
    ds_read_b128 v[56:59], v5 offset:10368
    ds_read_b128 v[60:63], v5 offset:10432
    ds_read_b128 v[64:67], v5 offset:10496
    s_waitcnt lgkmcnt(5)
    v_mfma_f32_16x16x32_bf16 v[26:29], v[68:71], v[132:135], v[26:29]
    v_mfma_f32_16x16x32_bf16 v[30:33], v[72:75], v[132:135], v[30:33]
    v_mfma_f32_16x16x32_bf16 v[34:37], v[76:79], v[132:135], v[34:37]
    v_mfma_f32_16x16x32_bf16 v[38:41], v[80:83], v[132:135], v[38:41]
    v_mfma_f32_16x16x32_bf16 v[42:45], v[84:87], v[132:135], v[42:45]
    ds_read_b128 v[68:71], v5 offset:15360
    ds_read_b128 v[72:75], v5 offset:15424
    ds_read_b128 v[76:79], v5 offset:15488
    ds_read_b128 v[80:83], v5 offset:15552
    ds_read_b128 v[84:87], v5 offset:15616
    s_waitcnt vmcnt(4)
G_OC_88:
    v_max3_u32 v18, v136, v137, v138
    v_max3_u32 v19, v139, v140, v141
    v_max3_u32 v18, v18, v142, v143
    v_max3_u32 v19, v19, v144, v145
    v_max3_u32 v18, v18, v146, v147
    v_max3_u32 v19, v19, v148, v149
    v_max3_u32 v18, v18, v150, v151
    v_max_u32 v18, v18, v19
    v_cmp_eq_u32 vcc, -1, v18
    s_nop 1
    s_cmp_eq_u64 vcc, 0
    s_cbranch_scc0 G_OS_89
G_OB_90:
    s_waitcnt lgkmcnt(5)
    v_mfma_f32_16x16x32_bf16 v[26:29], v[48:51], v[136:139], v[26:29]
    v_mfma_f32_16x16x32_bf16 v[30:33], v[52:55], v[136:139], v[30:33]
    v_mfma_f32_16x16x32_bf16 v[34:37], v[56:59], v[136:139], v[34:37]
    v_mfma_f32_16x16x32_bf16 v[38:41], v[60:63], v[136:139], v[38:41]
    v_mfma_f32_16x16x32_bf16 v[42:45], v[64:67], v[136:139], v[42:45]
    ds_read_b128 v[48:51], v5 offset:20480
    ds_read_b128 v[52:55], v5 offset:20544
    ds_read_b128 v[56:59], v5 offset:20608
    ds_read_b128 v[60:63], v5 offset:20672
    ds_read_b128 v[64:67], v5 offset:20736
    s_waitcnt lgkmcnt(5)
    v_mfma_f32_16x16x32_bf16 v[26:29], v[68:71], v[140:143], v[26:29]
    v_mfma_f32_16x16x32_bf16 v[30:33], v[72:75], v[140:143], v[30:33]
    v_mfma_f32_16x16x32_bf16 v[34:37], v[76:79], v[140:143], v[34:37]
    v_mfma_f32_16x16x32_bf16 v[38:41], v[80:83], v[140:143], v[38:41]
    v_mfma_f32_16x16x32_bf16 v[42:45], v[84:87], v[140:143], v[42:45]
    ds_read_b128 v[68:71], v5 offset:25600
    ds_read_b128 v[72:75], v5 offset:25664
    ds_read_b128 v[76:79], v5 offset:25728
    ds_read_b128 v[80:83], v5 offset:25792
    ds_read_b128 v[84:87], v5 offset:25856
    s_waitcnt lgkmcnt(5)
    v_mfma_f32_16x16x32_bf16 v[26:29], v[48:51], v[144:147], v[26:29]
    v_mfma_f32_16x16x32_bf16 v[30:33], v[52:55], v[144:147], v[30:33]
    v_mfma_f32_16x16x32_bf16 v[34:37], v[56:59], v[144:147], v[34:37]
    v_mfma_f32_16x16x32_bf16 v[38:41], v[60:63], v[144:147], v[38:41]
    v_mfma_f32_16x16x32_bf16 v[42:45], v[64:67], v[144:147], v[42:45]
    ds_read_b128 v[48:51], v5 offset:30720
    ds_read_b128 v[52:55], v5 offset:30784
    ds_read_b128 v[56:59], v5 offset:30848
    ds_read_b128 v[60:63], v5 offset:30912
    ds_read_b128 v[64:67], v5 offset:30976
    s_waitcnt lgkmcnt(5)
    v_mfma_f32_16x16x32_bf16 v[26:29], v[68:71], v[148:151], v[26:29]
    v_mfma_f32_16x16x32_bf16 v[30:33], v[72:75], v[148:151], v[30:33]
    v_mfma_f32_16x16x32_bf16 v[34:37], v[76:79], v[148:151], v[34:37]
    v_mfma_f32_16x16x32_bf16 v[38:41], v[80:83], v[148:151], v[38:41]
    v_mfma_f32_16x16x32_bf16 v[42:45], v[84:87], v[148:151], v[42:45]
    ds_read_b128 v[68:71], v5 offset:35840
    ds_read_b128 v[72:75], v5 offset:35904
    ds_read_b128 v[76:79], v5 offset:35968
    ds_read_b128 v[80:83], v5 offset:36032
    ds_read_b128 v[84:87], v5 offset:36096
    s_waitcnt vmcnt(0)
G_OC_91:
    v_max3_u32 v18, v152, v153, v154
    v_max3_u32 v19, v155, v156, v157
    v_max3_u32 v18, v18, v158, v159
    v_max3_u32 v19, v19, v160, v161
    v_max3_u32 v18, v18, v162, v163
    v_max3_u32 v19, v19, v164, v165
    v_max3_u32 v18, v18, v166, v167
    v_max_u32 v18, v18, v19
    v_cmp_eq_u32 vcc, -1, v18
    s_nop 1
    s_cmp_eq_u64 vcc, 0
    s_cbranch_scc0 G_OS_92
G_OB_93:
    s_waitcnt lgkmcnt(5)
    v_mfma_f32_16x16x32_bf16 v[26:29], v[48:51], v[152:155], v[26:29]
    v_mfma_f32_16x16x32_bf16 v[30:33], v[52:55], v[152:155], v[30:33]
    v_mfma_f32_16x16x32_bf16 v[34:37], v[56:59], v[152:155], v[34:37]
    v_mfma_f32_16x16x32_bf16 v[38:41], v[60:63], v[152:155], v[38:41]
    v_mfma_f32_16x16x32_bf16 v[42:45], v[64:67], v[152:155], v[42:45]
    ds_read_b128 v[48:51], v5 offset:40960
    ds_read_b128 v[52:55], v5 offset:41024
    ds_read_b128 v[56:59], v5 offset:41088
    ds_read_b128 v[60:63], v5 offset:41152
    ds_read_b128 v[64:67], v5 offset:41216
    s_waitcnt lgkmcnt(5)
    v_mfma_f32_16x16x32_bf16 v[26:29], v[68:71], v[156:159], v[26:29]
    v_mfma_f32_16x16x32_bf16 v[30:33], v[72:75], v[156:159], v[30:33]
    v_mfma_f32_16x16x32_bf16 v[34:37], v[76:79], v[156:159], v[34:37]
    v_mfma_f32_16x16x32_bf16 v[38:41], v[80:83], v[156:159], v[38:41]
    v_mfma_f32_16x16x32_bf16 v[42:45], v[84:87], v[156:159], v[42:45]
    ds_read_b128 v[68:71], v5 offset:46080
    ds_read_b128 v[72:75], v5 offset:46144
    ds_read_b128 v[76:79], v5 offset:46208
    ds_read_b128 v[80:83], v5 offset:46272
    ds_read_b128 v[84:87], v5 offset:46336
    s_waitcnt lgkmcnt(5)
    v_mfma_f32_16x16x32_bf16 v[26:29], v[48:51], v[160:163], v[26:29]
    v_mfma_f32_16x16x32_bf16 v[30:33], v[52:55], v[160:163], v[30:33]
    v_mfma_f32_16x16x32_bf16 v[34:37], v[56:59], v[160:163], v[34:37]
    v_mfma_f32_16x16x32_bf16 v[38:41], v[60:63], v[160:163], v[38:41]
    v_mfma_f32_16x16x32_bf16 v[42:45], v[64:67], v[160:163], v[42:45]
    s_waitcnt lgkmcnt(0)
    v_mfma_f32_16x16x32_bf16 v[26:29], v[68:71], v[164:167], v[26:29]
    v_mfma_f32_16x16x32_bf16 v[30:33], v[72:75], v[164:167], v[30:33]
    v_mfma_f32_16x16x32_bf16 v[34:37], v[76:79], v[164:167], v[34:37]
    v_mfma_f32_16x16x32_bf16 v[38:41], v[80:83], v[164:167], v[38:41]
    v_mfma_f32_16x16x32_bf16 v[42:45], v[84:87], v[164:167], v[42:45]
    s_cmp_lg_u32 s65, 0
    s_cbranch_scc1 G_FIN
    s_add_u32 s54, s54, 2621440
    s_mov_b32 s64, 8
    s_mov_b32 s65, 4096
    v_mov_b32 v5, v4
    v_add_u32 v4, 102400, v4
    v_mov_b32 v6, 163516
    s_branch G_PASS2
G_FIN:
    s_mov_b32 s40, s22
    s_mov_b32 s41, s23
    s_mov_b32 s42, 2621440
    s_mov_b32 s43, 0x20000
    s_lshl_b32 s56, s29, 6
    s_lshl_b32 s57, s52, 4
    s_add_u32 s56, s56, s57
    v_add_u32 v2, s56, v14
    v_mul_u32_u24 v2, 1280, v2
    s_mul_i32 s56, s30, 160
    v_mul_u32_u24 v3, 40, v15
    v_add3_u32 v2, v2, v3, s56
    v_cvt_pk_bf16_f32 v48, v26, v27
    v_cvt_pk_bf16_f32 v49, v28, v29
    v_cvt_pk_bf16_f32 v50, v30, v31
    v_cvt_pk_bf16_f32 v51, v32, v33
    v_cvt_pk_bf16_f32 v52, v34, v35
    v_cvt_pk_bf16_f32 v53, v36, v37
    v_cvt_pk_bf16_f32 v54, v38, v39
    v_cvt_pk_bf16_f32 v55, v40, v41
    v_cvt_pk_bf16_f32 v56, v42, v43
    v_cvt_pk_bf16_f32 v57, v44, v45
    buffer_store_dwordx4 v[48:51], v2, s[40:43], 0 offen
    buffer_store_dwordx4 v[52:55], v2, s[40:43], 0 offen offset:16
    buffer_store_dwordx2 v[56:57], v2, s[40:43], 0 offen offset:32
    s_endpgm
G_OS_80:
    s_sleep 1
    buffer_load_dwordx4 v[88:91], v2, s[32:35], s88 offen offset:0 sc1
    buffer_load_dwordx4 v[92:95], v2, s[32:35], s88 offen offset:1024 sc1
    buffer_load_dwordx4 v[96:99], v2, s[32:35], s88 offen offset:2048 sc1
    buffer_load_dwordx4 v[100:103], v2, s[32:35], s88 offen offset:3072 sc1
    s_waitcnt vmcnt(0)
    s_sub_u32 s71, s71, 1
    s_cbranch_scc0 G_OC_79
    s_mov_b32 s71, 0
    s_branch G_OB_81
G_OS_83:
    s_sleep 1
    buffer_load_dwordx4 v[104:107], v2, s[32:35], s89 offen offset:0 sc1
    buffer_load_dwordx4 v[108:111], v2, s[32:35], s89 offen offset:1024 sc1
    buffer_load_dwordx4 v[112:115], v2, s[32:35], s89 offen offset:2048 sc1
    buffer_load_dwordx4 v[116:119], v2, s[32:35], s89 offen offset:3072 sc1
    s_waitcnt vmcnt(0)
    s_sub_u32 s71, s71, 1
    s_cbranch_scc0 G_OC_82
    s_mov_b32 s71, 0
    s_branch G_OB_84
G_OS_86:
    s_sleep 1
    buffer_load_dwordx4 v[120:123], v2, s[32:35], s90 offen offset:0 sc1
    buffer_load_dwordx4 v[124:127], v2, s[32:35], s90 offen offset:1024 sc1
    buffer_load_dwordx4 v[128:131], v2, s[32:35], s90 offen offset:2048 sc1
    buffer_load_dwordx4 v[132:135], v2, s[32:35], s90 offen offset:3072 sc1
    s_waitcnt vmcnt(0)
    s_sub_u32 s71, s71, 1
    s_cbranch_scc0 G_OC_85
    s_mov_b32 s71, 0
    s_branch G_OB_87
G_OS_89:
    s_sleep 1
    buffer_load_dwordx4 v[136:139], v2, s[32:35], s91 offen offset:0 sc1
    buffer_load_dwordx4 v[140:143], v2, s[32:35], s91 offen offset:1024 sc1
    buffer_load_dwordx4 v[144:147], v2, s[32:35], s91 offen offset:2048 sc1
    buffer_load_dwordx4 v[148:151], v2, s[32:35], s91 offen offset:3072 sc1
    s_waitcnt vmcnt(0)
    s_sub_u32 s71, s71, 1
    s_cbranch_scc0 G_OC_88
    s_mov_b32 s71, 0
    s_branch G_OB_90
G_OS_92:
    s_sleep 1
    buffer_load_dwordx4 v[152:155], v2, s[32:35], s92 offen offset:0 sc1
    buffer_load_dwordx4 v[156:159], v2, s[32:35], s92 offen offset:1024 sc1
    buffer_load_dwordx4 v[160:163], v2, s[32:35], s92 offen offset:2048 sc1
    buffer_load_dwordx4 v[164:167], v2, s[32:35], s92 offen offset:3072 sc1
    s_waitcnt vmcnt(0)
    s_sub_u32 s71, s71, 1
    s_cbranch_scc0 G_OC_91
    s_mov_b32 s71, 0
    s_branch G_OB_93
F_FALLBACK:
    v_lshlrev_b32 v19, 4, v1
    v_lshlrev_b32 v20, 3, v2
    v_add_u32 v20, 1024, v20
    v_min_u32 v4, 21, v2
    v_mul_u32_u24 v5, 22, v3
    v_add_u32 v4, v4, v5
    v_lshlrev_b32 v21, 4, v4
    v_add_u32 v21, 1280, v21
    v_cmp_eq_u32 vcc, s67, v3
    s_cmp_eq_u32 s67, 0
    s_cbranch_scc1 F_FB0
    v_mov_b32 v8, v12
    v_mov_b32 v9, v13
    v_mov_b32 v10, v14
    v_mov_b32 v11, v15
F_FB0:
    v_cndmask_b32 v16, 0, v16, vcc
    v_cndmask_b32 v17, 0, v17, vcc
    v_mov_b32 v4, 0xff800000
    s_mov_b32 s56, 0
F_FB1:
    buffer_load_dwordx4 v[28:31], v19, s[32:35], s56 offen sc1
    buffer_load_dwordx2 v[26:27], v20, s[32:35], s56 offen sc1
    s_waitcnt vmcnt(0)
    v_mfma_f32_32x32x16_bf16 v[104:119], v[28:31], v[8:11], 0
    v_mfma_f32_32x32x8_bf16 v[104:119], v[26:27], v[16:17], v[104:119]
    s_nop 15
    v_max3_f32 v4, v4, v104, v105
    v_max3_f32 v4, v4, v106, v107
    v_max3_f32 v4, v4, v108, v109
    v_max3_f32 v4, v4, v110, v111
    v_max3_f32 v4, v4, v112, v113
    v_max3_f32 v4, v4, v114, v115
    v_max3_f32 v4, v4, v116, v117
    v_max3_f32 v4, v4, v118, v119
    s_add_u32 s56, s56, 2688
    s_cmp_lt_u32 s56, 172032
    s_cbranch_scc1 F_FB1
    v_mov_b32 v5, v4
    s_nop 1
    v_permlane32_swap_b32 v4, v5
    s_nop 1
    v_max_f32 v4, v4, v5
    v_sub_f32 v4, 0, v4
    v_mov_b32 v40, v4
    v_mov_b32 v136, 0
    v_mov_b32 v41, v4
    v_mov_b32 v137, 0
    v_mov_b32 v42, v4
    v_mov_b32 v138, 0
    v_mov_b32 v43, v4
    v_mov_b32 v139, 0
    v_mov_b32 v44, v4
    v_mov_b32 v140, 0
    v_mov_b32 v45, v4
    v_mov_b32 v141, 0
    v_mov_b32 v46, v4
    v_mov_b32 v142, 0
    v_mov_b32 v47, v4
    v_mov_b32 v143, 0
    v_mov_b32 v48, v4
    v_mov_b32 v144, 0
    v_mov_b32 v49, v4
    v_mov_b32 v145, 0
    v_mov_b32 v50, v4
    v_mov_b32 v146, 0
    v_mov_b32 v51, v4
    v_mov_b32 v147, 0
    v_mov_b32 v52, v4
    v_mov_b32 v148, 0
    v_mov_b32 v53, v4
    v_mov_b32 v149, 0
    v_mov_b32 v54, v4
    v_mov_b32 v150, 0
    v_mov_b32 v55, v4
    v_mov_b32 v151, 0
    s_mov_b32 s56, 0
F_FB2:
    buffer_load_dwordx4 v[28:31], v19, s[32:35], s56 offen sc1
    buffer_load_dwordx2 v[26:27], v20, s[32:35], s56 offen sc1
    buffer_load_dwordx4 v[32:35], v21, s[32:35], s56 offen sc1
    buffer_load_dwordx4 v[36:39], v21, s[32:35], s56 offen offset:704 sc1
    s_waitcnt vmcnt(0)
    v_mfma_f32_32x32x16_bf16 v[104:119], v[28:31], v[8:11], v[40:55]
    v_mfma_f32_32x32x8_bf16 v[104:119], v[26:27], v[16:17], v[104:119]
    s_nop 15
    v_exp_f32 v104, v104
    v_exp_f32 v105, v105
    v_exp_f32 v106, v106
    v_exp_f32 v107, v107
    v_exp_f32 v108, v108
    v_exp_f32 v109, v109
    v_exp_f32 v110, v110
    v_exp_f32 v111, v111
    v_exp_f32 v112, v112
    v_exp_f32 v113, v113
    v_exp_f32 v114, v114
    v_exp_f32 v115, v115
    v_exp_f32 v116, v116
    v_exp_f32 v117, v117
    v_exp_f32 v118, v118
    v_exp_f32 v119, v119
    s_nop 3
    v_smfmac_f32_32x32x32_bf16 v[136:151], v[32:35], v[104:111], v18
    v_smfmac_f32_32x32x32_bf16 v[136:151], v[36:39], v[112:119], v18
    s_add_u32 s56, s56, 2688
    s_cmp_lt_u32 s56, 172032
    s_nop 7
    s_cbranch_scc1 F_FB2
    s_nop 15
    v_mov_b32 v88, v136
    v_mov_b32 v89, v137
    v_mov_b32 v90, v138
    v_mov_b32 v91, v139
    v_mov_b32 v92, v140
    v_mov_b32 v93, v141
    v_mov_b32 v94, v142
    v_mov_b32 v95, v143
    v_mov_b32 v96, v144
    v_mov_b32 v97, v145
    v_mov_b32 v98, v146
    v_mov_b32 v99, v147
    v_mov_b32 v4, v96
    v_mov_b32 v5, v96
    s_nop 1
    v_permlane32_swap_b32 v4, v5
    s_nop 1
    s_branch F_FIN2
F_END:
    s_endpgm
.section .rodata,"a"
.p2align 6
.amdhsa_kernel fused_kernel
  .amdhsa_next_free_vgpr 168
  .amdhsa_next_free_sgpr 100
  .amdhsa_accum_offset 168
  .amdhsa_group_segment_fixed_size 0
  .amdhsa_kernarg_size 104
  .amdhsa_user_sgpr_count 2
  .amdhsa_user_sgpr_kernarg_segment_ptr 1
  .amdhsa_system_sgpr_workgroup_id_x 1
.end_amdhsa_kernel
```
